```python
import torch

def _softmax(x, axis=-1):
    return torch.softmax(x, dim=axis)
def _gelu(x):
    return torch.nn.functional.gelu(x, approximate="tanh")
def _silu(x):
    return torch.nn.functional.silu(x)
def _sigmoid(x):
    return torch.sigmoid(x)
def _layernorm(x, axis=-1, eps=1e-5):
    m = x.mean(dim=axis, keepdim=True)
    v = x.var(dim=axis, keepdim=True, unbiased=False)
    return (x - m) / torch.sqrt(v + eps)
def _scatter_add(tgt, idx, src, axis=0):
    return tgt.clone().index_add_(axis, idx, src)
def _segment_sum(src, seg, n):
    out = torch.zeros((n,) + src.shape[1:], dtype=src.dtype)
    return out.index_add_(0, seg, src)
def _pad(x, pw):
    flat = tuple(v for pair in reversed(pw) for v in pair)
    return torch.nn.functional.pad(x, flat)

kernel_name = 'parallel_sum__mha_block__swiglu_ffn__prompt'

def setup_inputs():

    _w = (lambda a: (lambda t: t.to(torch.bfloat16) if t.is_floating_point() else t)(torch.as_tensor(a)))
    def _A_setup():
        B, S, D, H = 1, 2048, 640, 32
        return {
            "x": _w((lambda *s: torch.randn(*s, dtype=torch.bfloat16) * 0.05)(B, S, D)),
            "wqkv": _w((lambda *s: torch.randn(*s, dtype=torch.bfloat16) * 0.2)(D, 3 * D)),
            "wo": _w((lambda *s: torch.randn(*s, dtype=torch.bfloat16) * 0.1)(D, D)),
        }
    _A_in = _A_setup()

    def _B_setup():
        B, S, D, F = 1, 2048, 640, 1536
        return {
            "x": _w((lambda *s: torch.randn(*s, dtype=torch.bfloat16) * 0.05)(B, S, D)),
            "w_gate": _w((lambda *s: torch.randn(*s, dtype=torch.bfloat16) * 0.1)(D, F)),
            "w_up": _w((lambda *s: torch.randn(*s, dtype=torch.bfloat16) * 0.1)(D, F)),
            "w_down": _w((lambda *s: torch.randn(*s, dtype=torch.bfloat16) * 0.1)(F, D)),
        }
    _B_in = _B_setup()

    return {
        "A_x": _A_in["x"],
        "A_wqkv": _A_in["wqkv"],
        "A_wo": _A_in["wo"],
        "B_x": _B_in["x"],
        "B_w_gate": _B_in["w_gate"],
        "B_w_up": _B_in["w_up"],
        "B_w_down": _B_in["w_down"],
    }

def reference(A_x, A_wqkv, A_wo, B_x, B_w_gate, B_w_up, B_w_down):
    def _A_ref(x, wqkv, wo):
        B, S, D = x.shape
        H = 32
        Dh = D // H
        qkv = (lambda x, *d: x.permute(*d))((x @ wqkv).reshape(B, S, 3, H, Dh), 2, 0, 3, 1, 4)
        q, k, v = qkv[0], qkv[1], qkv[2]
        scores = torch.einsum("bhqd,bhkd->bhqk", q, k) * (Dh ** -0.5)
        p = _softmax(scores, axis=-1)
        o = torch.einsum("bhqk,bhkd->bhqd", p, v)
        return (lambda x, *d: x.permute(*d))(o, 0, 2, 1, 3).reshape(B, S, D) @ wo

    def _B_ref(x, w_gate, w_up, w_down):
        g = _silu(x @ w_gate)
        u = x @ w_up
        return (g * u) @ w_down

    x = A_x
    xn = _layernorm(x, axis=-1)
    return x + _A_ref(xn, A_wqkv, A_wo) + _B_ref(xn, B_w_gate, B_w_up, B_w_down)
```

```asm
; @launch kernel=proj_kernel grid=(256,1,1) block=(512,1,1) lds=153920
; @launch kernel=main_kernel grid=(256,1,1) block=(768,1,1) lds=149248
.amdgcn_target "amdgcn-amd-amdhsa--gfx950"
.text
.globl proj_kernel
.p2align 8
.type proj_kernel,@function
proj_kernel:
    s_cmp_ge_u32 s2, 256
    s_cbranch_scc1 L_k1_end
    s_load_dwordx4 s[4:7], s[0:1], 0
    s_load_dwordx4 s[36:39], s[0:1], 32
    s_load_dwordx2 s[40:41], s[0:1], 72
    s_load_dwordx2 s[66:67], s[0:1], 64
    v_lshrrev_b32 v1, 6, v0
    v_and_b32 v2, 63, v0
    v_readfirstlane_b32 s28, v1
    s_and_b32 s31, s2, 7
    s_lshr_b32 s32, s2, 3
    s_and_b32 s29, s31, 1
    s_lshl_b32 s29, s29, 3
    s_and_b32 s33, s32, 7
    s_add_u32 s29, s29, s33
    s_lshr_b32 s30, s31, 1
    s_lshl_b32 s30, s30, 2
    s_lshr_b32 s33, s32, 3
    s_add_u32 s30, s30, s33
    s_and_b32 s35, s30, 7
    s_waitcnt lgkmcnt(0)
    s_mov_b32 s8, s4
    s_and_b32 s9, s5, 0xffff
    s_mov_b32 s10, 2621440
    s_mov_b32 s11, 0x00020000
    s_mov_b32 s12, s6
    s_and_b32 s13, s7, 0xffff
    s_mov_b32 s14, 2457600
    s_mov_b32 s15, 0x00020000
    s_mov_b32 s16, s36
    s_and_b32 s17, s37, 0xffff
    s_mov_b32 s18, 1966080
    s_mov_b32 s19, 0x00020000
    s_mov_b32 s20, s38
    s_and_b32 s21, s39, 0xffff
    s_mov_b32 s22, 1966080
    s_mov_b32 s23, 0x00020000
    s_mov_b32 s24, s40
    s_and_b32 s25, s41, 0xffff
    s_mov_b32 s26, 27262976
    s_mov_b32 s27, 0x00020000
    s_cmp_ge_u32 s28, 4
    s_cbranch_scc1 L_k1_loader
    s_lshr_b32 s42, s28, 1
    s_and_b32 s43, s28, 1
    s_lshl_b32 s31, s42, 1
    s_add_u32 s44, s31, s43
    s_xor_b32 s45, s44, 1
    v_and_b32 v3, 31, v2
    v_lshrrev_b32 v4, 5, v2
    v_bfe_u32 v26, v3, 1, 3
    v_xor_b32 v26, v26, v4
    v_lshlrev_b32 v26, 4, v26
    v_lshl_add_u32 v26, v3, 7, v26
    s_lshl_b32 s31, s44, 12
    v_add_u32 v5, s31, v26
    v_xor_b32 v6, 32, v5
    v_xor_b32 v7, 64, v5
    v_xor_b32 v8, 96, v5
    s_lshl_b32 s31, s45, 12
    v_add_u32 v9, s31, v26
    v_xor_b32 v10, 32, v9
    v_xor_b32 v11, 64, v9
    v_xor_b32 v12, 96, v9
    s_cmp_eq_u32 s42, 0
    s_cbranch_scc1 L_k1_norows
    v_mul_u32_u24 v26, 1280, v4
    v_lshl_add_u32 v26, v3, 4, v26
    v_cmp_gt_u32 vcc, 16, v3
    v_add_u32 v27, 1024, v26
    v_mov_b32 v28, 0x7ff00000
    s_lshl_b32 s31, s29, 7
    s_lshl_b32 s32, s30, 3
    s_add_u32 s31, s31, s32
    s_lshl_b32 s32, s43, 2
    s_add_u32 s34, s31, s32
    v_cndmask_b32 v27, v28, v27, vcc
    s_mul_i32 s31, s34, 1280
    buffer_load_dwordx4 v[96:99], v26, s[8:11], s31 offen
    buffer_load_dwordx4 v[100:103], v26, s[8:11], s31 offen offset:512
    buffer_load_dwordx4 v[104:107], v27, s[8:11], s31 offen
    s_add_u32 s31, s31, 2560
    buffer_load_dwordx4 v[108:111], v26, s[8:11], s31 offen
    buffer_load_dwordx4 v[112:115], v26, s[8:11], s31 offen offset:512
    buffer_load_dwordx4 v[116:119], v27, s[8:11], s31 offen
L_k1_norows:
    s_cmp_ge_u32 s30, 8
    s_cbranch_scc1 L_k1_main1
    v_bfe_u32 v26, v2, 2, 2
    v_lshrrev_b32 v27, 5, v2
    v_lshl_add_u32 v27, v27, 3, v26
    v_bfe_u32 v28, v2, 4, 1
    v_lshlrev_b32 v28, 5, v28
    v_and_b32 v29, 3, v2
    v_lshl_add_u32 v28, v29, 3, v28
    s_mul_i32 s64, s43, 1
    s_add_u32 s64, s64, 0
    v_lshrrev_b32 v29, 1, v26
    v_xor_b32 v29, s64, v29
    v_lshl_add_u32 v29, v29, 6, v28
    v_mul_u32_u24 v13, 128, v27
    v_add_u32 v13, v13, v29
    v_add_u32 v13, 49152, v13
    s_mul_i32 s64, s43, 2
    s_add_u32 s64, s64, 0
    v_xor_b32 v29, s64, v26
    v_lshl_add_u32 v29, v29, 6, v28
    v_mul_u32_u24 v14, 256, v27
    v_add_u32 v14, v14, v29
    v_add_u32 v14, 53248, v14
    s_mul_i32 s64, s43, 2
    s_add_u32 s64, s64, 0
    v_xor_b32 v29, s64, v26
    v_lshl_add_u32 v29, v29, 6, v28
    v_mul_u32_u24 v15, 256, v27
    v_add_u32 v15, v15, v29
    v_add_u32 v15, 61440, v15
    s_mul_i32 s64, s43, 2
    s_add_u32 s64, s64, 1
    v_xor_b32 v29, s64, v26
    v_lshl_add_u32 v29, v29, 6, v28
    v_mul_u32_u24 v16, 256, v27
    v_add_u32 v16, v16, v29
    v_add_u32 v16, 53248, v16
    s_mul_i32 s64, s43, 2
    s_add_u32 s64, s64, 1
    v_xor_b32 v29, s64, v26
    v_lshl_add_u32 v29, v29, 6, v28
    v_mul_u32_u24 v17, 256, v27
    v_add_u32 v17, v17, v29
    v_add_u32 v17, 61440, v17
    s_getpc_b64 s[46:47]
L_pc_k1_0:
    s_add_u32 s46, s46, L_k1_loop0-L_pc_k1_0
    s_addc_u32 s47, s47, 0
    v_lshlrev_b32 v92, 4, v2
    global_load_dwordx4 v[88:91], v92, s[46:47]
    v_add_u32 v92, 1024, v92
    global_load_dwordx4 v[88:91], v92, s[46:47]
    v_add_u32 v92, 1024, v92
    global_load_dwordx4 v[88:91], v92, s[46:47]
    v_add_u32 v92, 1024, v92
    global_load_dwordx4 v[88:91], v92, s[46:47]
    s_getpc_b64 s[46:47]
L_pc_k1_0e:
    s_add_u32 s46, s46, L_k1_post-L_pc_k1_0e
    s_addc_u32 s47, s47, 0
    v_lshlrev_b32 v92, 4, v2
    global_load_dwordx4 v[88:91], v92, s[46:47]
    v_add_u32 v92, 1024, v92
    global_load_dwordx4 v[88:91], v92, s[46:47]
    v_add_u32 v92, 1024, v92
    global_load_dwordx4 v[88:91], v92, s[46:47]
    v_add_u32 v92, 1024, v92
    global_load_dwordx4 v[88:91], v92, s[46:47]
    v_add_u32 v92, 1024, v92
    global_load_dwordx4 v[88:91], v92, s[46:47]
    v_add_u32 v92, 1024, v92
    global_load_dwordx4 v[88:91], v92, s[46:47]
    v_add_u32 v92, 1024, v92
    global_load_dwordx4 v[88:91], v92, s[46:47]
    v_add_u32 v92, 1024, v92
    global_load_dwordx4 v[88:91], v92, s[46:47]
    s_cmp_eq_u32 s42, 0
    s_cbranch_scc1 L_k1_sjd0
    s_waitcnt vmcnt(0)
    v_lshlrev_b32 v122, 16, v96
    v_and_b32 v123, 0xffff0000, v96
    v_add_f32 v120, v122, v123
    v_mul_f32 v121, v122, v122
    v_fmac_f32 v121, v123, v123
    v_lshlrev_b32 v124, 16, v97
    v_and_b32 v125, 0xffff0000, v97
    v_add_f32 v120, v120, v124
    v_fmac_f32 v121, v124, v124
    v_add_f32 v120, v120, v125
    v_fmac_f32 v121, v125, v125
    v_lshlrev_b32 v122, 16, v98
    v_and_b32 v123, 0xffff0000, v98
    v_add_f32 v120, v120, v122
    v_fmac_f32 v121, v122, v122
    v_add_f32 v120, v120, v123
    v_fmac_f32 v121, v123, v123
    v_lshlrev_b32 v124, 16, v99
    v_and_b32 v125, 0xffff0000, v99
    v_add_f32 v120, v120, v124
    v_fmac_f32 v121, v124, v124
    v_add_f32 v120, v120, v125
    v_fmac_f32 v121, v125, v125
    v_lshlrev_b32 v122, 16, v100
    v_and_b32 v123, 0xffff0000, v100
    v_add_f32 v120, v120, v122
    v_fmac_f32 v121, v122, v122
    v_add_f32 v120, v120, v123
    v_fmac_f32 v121, v123, v123
    v_lshlrev_b32 v124, 16, v101
    v_and_b32 v125, 0xffff0000, v101
    v_add_f32 v120, v120, v124
    v_fmac_f32 v121, v124, v124
    v_add_f32 v120, v120, v125
    v_fmac_f32 v121, v125, v125
    v_lshlrev_b32 v122, 16, v102
    v_and_b32 v123, 0xffff0000, v102
    v_add_f32 v120, v120, v122
    v_fmac_f32 v121, v122, v122
    v_add_f32 v120, v120, v123
    v_fmac_f32 v121, v123, v123
    v_lshlrev_b32 v124, 16, v103
    v_and_b32 v125, 0xffff0000, v103
    v_add_f32 v120, v120, v124
    v_fmac_f32 v121, v124, v124
    v_add_f32 v120, v120, v125
    v_fmac_f32 v121, v125, v125
    v_lshlrev_b32 v122, 16, v104
    v_and_b32 v123, 0xffff0000, v104
    v_add_f32 v120, v120, v122
    v_fmac_f32 v121, v122, v122
    v_add_f32 v120, v120, v123
    v_fmac_f32 v121, v123, v123
    v_lshlrev_b32 v124, 16, v105
    v_and_b32 v125, 0xffff0000, v105
    v_add_f32 v120, v120, v124
    v_fmac_f32 v121, v124, v124
    v_add_f32 v120, v120, v125
    v_fmac_f32 v121, v125, v125
    v_lshlrev_b32 v122, 16, v106
    v_and_b32 v123, 0xffff0000, v106
    v_add_f32 v120, v120, v122
    v_fmac_f32 v121, v122, v122
    v_add_f32 v120, v120, v123
    v_fmac_f32 v121, v123, v123
    v_lshlrev_b32 v124, 16, v107
    v_and_b32 v125, 0xffff0000, v107
    v_add_f32 v120, v120, v124
    v_fmac_f32 v121, v124, v124
    v_add_f32 v120, v120, v125
    v_fmac_f32 v121, v125, v125
    s_nop 1
    v_add_f32_dpp v120, v120, v120 row_ror:8 row_mask:0xf bank_mask:0xf
    v_add_f32_dpp v121, v121, v121 row_ror:8 row_mask:0xf bank_mask:0xf
    s_nop 1
    v_add_f32_dpp v120, v120, v120 row_ror:4 row_mask:0xf bank_mask:0xf
    v_add_f32_dpp v121, v121, v121 row_ror:4 row_mask:0xf bank_mask:0xf
    s_nop 1
    v_add_f32_dpp v120, v120, v120 row_ror:2 row_mask:0xf bank_mask:0xf
    v_add_f32_dpp v121, v121, v121 row_ror:2 row_mask:0xf bank_mask:0xf
    s_nop 1
    v_add_f32_dpp v120, v120, v120 row_ror:1 row_mask:0xf bank_mask:0xf
    v_add_f32_dpp v121, v121, v121 row_ror:1 row_mask:0xf bank_mask:0xf
    v_mov_b32 v122, v120
    v_mov_b32 v123, v121
    s_nop 1
    v_permlane16_swap_b32 v122, v120
    v_permlane16_swap_b32 v123, v121
    s_nop 0
    v_add_f32 v120, v120, v122
    v_add_f32 v121, v121, v123
    v_mul_f32 v126, 0x3acccccd, v120
    v_mul_f32 v121, 0x3acccccd, v121
    v_fma_f32 v121, -v126, v126, v121
    v_max_f32 v121, 0, v121
    v_add_f32 v121, 0x3727c5ac, v121
    v_rsq_f32 v127, v121
    v_lshlrev_b32 v122, 16, v108
    v_and_b32 v123, 0xffff0000, v108
    v_add_f32 v120, v122, v123
    v_mul_f32 v121, v122, v122
    v_fmac_f32 v121, v123, v123
    v_lshlrev_b32 v124, 16, v109
    v_and_b32 v125, 0xffff0000, v109
    v_add_f32 v120, v120, v124
    v_fmac_f32 v121, v124, v124
    v_add_f32 v120, v120, v125
    v_fmac_f32 v121, v125, v125
    v_lshlrev_b32 v122, 16, v110
    v_and_b32 v123, 0xffff0000, v110
    v_add_f32 v120, v120, v122
    v_fmac_f32 v121, v122, v122
    v_add_f32 v120, v120, v123
    v_fmac_f32 v121, v123, v123
    v_lshlrev_b32 v124, 16, v111
    v_and_b32 v125, 0xffff0000, v111
    v_add_f32 v120, v120, v124
    v_fmac_f32 v121, v124, v124
    v_add_f32 v120, v120, v125
    v_fmac_f32 v121, v125, v125
    v_lshlrev_b32 v122, 16, v112
    v_and_b32 v123, 0xffff0000, v112
    v_add_f32 v120, v120, v122
    v_fmac_f32 v121, v122, v122
    v_add_f32 v120, v120, v123
    v_fmac_f32 v121, v123, v123
    v_lshlrev_b32 v124, 16, v113
    v_and_b32 v125, 0xffff0000, v113
    v_add_f32 v120, v120, v124
    v_fmac_f32 v121, v124, v124
    v_add_f32 v120, v120, v125
    v_fmac_f32 v121, v125, v125
    v_lshlrev_b32 v122, 16, v114
    v_and_b32 v123, 0xffff0000, v114
    v_add_f32 v120, v120, v122
    v_fmac_f32 v121, v122, v122
    v_add_f32 v120, v120, v123
    v_fmac_f32 v121, v123, v123
    v_lshlrev_b32 v124, 16, v115
    v_and_b32 v125, 0xffff0000, v115
    v_add_f32 v120, v120, v124
    v_fmac_f32 v121, v124, v124
    v_add_f32 v120, v120, v125
    v_fmac_f32 v121, v125, v125
    v_lshlrev_b32 v122, 16, v116
    v_and_b32 v123, 0xffff0000, v116
    v_add_f32 v120, v120, v122
    v_fmac_f32 v121, v122, v122
    v_add_f32 v120, v120, v123
    v_fmac_f32 v121, v123, v123
    v_lshlrev_b32 v124, 16, v117
    v_and_b32 v125, 0xffff0000, v117
    v_add_f32 v120, v120, v124
    v_fmac_f32 v121, v124, v124
    v_add_f32 v120, v120, v125
    v_fmac_f32 v121, v125, v125
    v_lshlrev_b32 v122, 16, v118
    v_and_b32 v123, 0xffff0000, v118
    v_add_f32 v120, v120, v122
    v_fmac_f32 v121, v122, v122
    v_add_f32 v120, v120, v123
    v_fmac_f32 v121, v123, v123
    v_lshlrev_b32 v124, 16, v119
    v_and_b32 v125, 0xffff0000, v119
    v_add_f32 v120, v120, v124
    v_fmac_f32 v121, v124, v124
    v_add_f32 v120, v120, v125
    v_fmac_f32 v121, v125, v125
    s_nop 1
    v_add_f32_dpp v120, v120, v120 row_ror:8 row_mask:0xf bank_mask:0xf
    v_add_f32_dpp v121, v121, v121 row_ror:8 row_mask:0xf bank_mask:0xf
    s_nop 1
    v_add_f32_dpp v120, v120, v120 row_ror:4 row_mask:0xf bank_mask:0xf
    v_add_f32_dpp v121, v121, v121 row_ror:4 row_mask:0xf bank_mask:0xf
    s_nop 1
    v_add_f32_dpp v120, v120, v120 row_ror:2 row_mask:0xf bank_mask:0xf
    v_add_f32_dpp v121, v121, v121 row_ror:2 row_mask:0xf bank_mask:0xf
    s_nop 1
    v_add_f32_dpp v120, v120, v120 row_ror:1 row_mask:0xf bank_mask:0xf
    v_add_f32_dpp v121, v121, v121 row_ror:1 row_mask:0xf bank_mask:0xf
    v_mov_b32 v122, v120
    v_mov_b32 v123, v121
    s_nop 1
    v_permlane16_swap_b32 v122, v120
    v_permlane16_swap_b32 v123, v121
    s_nop 0
    v_add_f32 v120, v120, v122
    v_add_f32 v121, v121, v123
    v_mul_f32 v128, 0x3acccccd, v120
    v_mul_f32 v121, 0x3acccccd, v121
    v_fma_f32 v121, -v128, v128, v121
    v_max_f32 v121, 0, v121
    v_add_f32 v121, 0x3727c5ac, v121
    v_rsq_f32 v129, v121
    v_lshlrev_b32 v26, 3, v4
    s_lshl_b32 s31, s34, 3
    s_add_u32 s31, s31, 11010048
    v_cmp_eq_u32 vcc, 0, v3
    s_nop 0
    s_and_saveexec_b64 s[68:69], vcc
    buffer_store_dwordx2 v[126:127], v26, s[24:27], s31 offen offset:0 sc1
    buffer_store_dwordx2 v[128:129], v26, s[24:27], s31 offen offset:16 sc1
    s_mov_b64 exec, -1
L_k1_sjd0:
    v_mov_b32 v96, 0
    v_mov_b32 v97, 0
    v_mov_b32 v98, 0
    v_mov_b32 v99, 0
    v_mov_b32 v100, 0
    v_mov_b32 v101, 0
    v_mov_b32 v102, 0
    v_mov_b32 v103, 0
    v_mov_b32 v104, 0
    v_mov_b32 v105, 0
    v_mov_b32 v106, 0
    v_mov_b32 v107, 0
    v_mov_b32 v108, 0
    v_mov_b32 v109, 0
    v_mov_b32 v110, 0
    v_mov_b32 v111, 0
    v_mov_b32 v112, 0
    v_mov_b32 v113, 0
    v_mov_b32 v114, 0
    v_mov_b32 v115, 0
    v_mov_b32 v116, 0
    v_mov_b32 v117, 0
    v_mov_b32 v118, 0
    v_mov_b32 v119, 0
    v_mov_b32 v120, 0
    v_mov_b32 v121, 0
    v_mov_b32 v122, 0
    v_mov_b32 v123, 0
    v_mov_b32 v124, 0
    v_mov_b32 v125, 0
    v_mov_b32 v126, 0
    v_mov_b32 v127, 0
    v_mov_b32 v128, 0
    v_mov_b32 v129, 0
    v_mov_b32 v130, 0
    v_mov_b32 v131, 0
    v_mov_b32 v132, 0
    v_mov_b32 v133, 0
    v_mov_b32 v134, 0
    v_mov_b32 v135, 0
    v_mov_b32 v136, 0
    v_mov_b32 v137, 0
    v_mov_b32 v138, 0
    v_mov_b32 v139, 0
    v_mov_b32 v140, 0
    v_mov_b32 v141, 0
    v_mov_b32 v142, 0
    v_mov_b32 v143, 0
    v_mov_b32 v144, 0
    v_mov_b32 v145, 0
    v_mov_b32 v146, 0
    v_mov_b32 v147, 0
    v_mov_b32 v148, 0
    v_mov_b32 v149, 0
    v_mov_b32 v150, 0
    v_mov_b32 v151, 0
    v_mov_b32 v152, 0
    v_mov_b32 v153, 0
    v_mov_b32 v154, 0
    v_mov_b32 v155, 0
    v_mov_b32 v156, 0
    v_mov_b32 v157, 0
    v_mov_b32 v158, 0
    v_mov_b32 v159, 0
    v_mov_b32 v160, 0
    v_mov_b32 v161, 0
    v_mov_b32 v162, 0
    v_mov_b32 v163, 0
    v_mov_b32 v164, 0
    v_mov_b32 v165, 0
    v_mov_b32 v166, 0
    v_mov_b32 v167, 0
    v_mov_b32 v168, 0
    v_mov_b32 v169, 0
    v_mov_b32 v170, 0
    v_mov_b32 v171, 0
    v_mov_b32 v172, 0
    v_mov_b32 v173, 0
    v_mov_b32 v174, 0
    v_mov_b32 v175, 0
    v_mov_b32 v176, 0
    v_mov_b32 v177, 0
    v_mov_b32 v178, 0
    v_mov_b32 v179, 0
    v_mov_b32 v180, 0
    v_mov_b32 v181, 0
    v_mov_b32 v182, 0
    v_mov_b32 v183, 0
    v_mov_b32 v184, 0
    v_mov_b32 v185, 0
    v_mov_b32 v186, 0
    v_mov_b32 v187, 0
    v_mov_b32 v188, 0
    v_mov_b32 v189, 0
    v_mov_b32 v190, 0
    v_mov_b32 v191, 0
    v_mov_b32 v192, 0
    v_mov_b32 v193, 0
    v_mov_b32 v194, 0
    v_mov_b32 v195, 0
    v_mov_b32 v196, 0
    v_mov_b32 v197, 0
    v_mov_b32 v198, 0
    v_mov_b32 v199, 0
    v_mov_b32 v200, 0
    v_mov_b32 v201, 0
    v_mov_b32 v202, 0
    v_mov_b32 v203, 0
    v_mov_b32 v204, 0
    v_mov_b32 v205, 0
    v_mov_b32 v206, 0
    v_mov_b32 v207, 0
    v_mov_b32 v208, 0
    v_mov_b32 v209, 0
    v_mov_b32 v210, 0
    v_mov_b32 v211, 0
    v_mov_b32 v212, 0
    v_mov_b32 v213, 0
    v_mov_b32 v214, 0
    v_mov_b32 v215, 0
    v_mov_b32 v216, 0
    v_mov_b32 v217, 0
    v_mov_b32 v218, 0
    v_mov_b32 v219, 0
    v_mov_b32 v220, 0
    v_mov_b32 v221, 0
    v_mov_b32 v222, 0
    v_mov_b32 v223, 0
    v_mov_b32 v224, 0
    v_mov_b32 v225, 0
    v_mov_b32 v226, 0
    v_mov_b32 v227, 0
    v_mov_b32 v228, 0
    v_mov_b32 v229, 0
    v_mov_b32 v230, 0
    v_mov_b32 v231, 0
    v_mov_b32 v232, 0
    v_mov_b32 v233, 0
    v_mov_b32 v234, 0
    v_mov_b32 v235, 0
    v_mov_b32 v236, 0
    v_mov_b32 v237, 0
    v_mov_b32 v238, 0
    v_mov_b32 v239, 0
    v_mov_b32 v240, 0
    v_mov_b32 v241, 0
    v_mov_b32 v242, 0
    v_mov_b32 v243, 0
    v_mov_b32 v244, 0
    v_mov_b32 v245, 0
    v_mov_b32 v246, 0
    v_mov_b32 v247, 0
    v_mov_b32 v248, 0
    v_mov_b32 v249, 0
    v_mov_b32 v250, 0
    v_mov_b32 v251, 0
    v_mov_b32 v252, 0
    v_mov_b32 v253, 0
    v_mov_b32 v254, 0
    v_mov_b32 v255, 0
    s_barrier
    ds_read_b128 v[32:35], v5
    ds_read_b128 v[36:39], v9
    ds_read_b64_tr_b16 v[40:41], v13 offset:0
    ds_read_b64_tr_b16 v[42:43], v13 offset:512
    ds_read_b64_tr_b16 v[44:45], v14 offset:0
    ds_read_b64_tr_b16 v[46:47], v14 offset:1024
    ds_read_b64_tr_b16 v[48:49], v15 offset:0
    ds_read_b64_tr_b16 v[50:51], v15 offset:1024
    ds_read_b64_tr_b16 v[52:53], v16 offset:0
    ds_read_b64_tr_b16 v[54:55], v16 offset:1024
    ds_read_b64_tr_b16 v[56:57], v17 offset:0
    ds_read_b64_tr_b16 v[58:59], v17 offset:1024
    s_mov_b32 s50, 0
    s_mov_b32 s51, 0
    s_mov_b32 s52, 10
    s_cmp_lt_u32 s29, 10
    s_cselect_b32 s31, 0, 1
    s_or_b32 s31, s31, s42
    s_cmp_lg_u32 s31, 0
    s_cbranch_scc1 L_k1_loop0
    v_mov_b32 v18, 0
    v_mov_b32 v19, 0
    v_mov_b32 v20, 0
    v_mov_b32 v21, 0
    v_mov_b32 v22, 0
    v_mov_b32 v23, 0x3f803f80
    s_nop 0
    s_waitcnt lgkmcnt(8)
    v_mfma_f32_32x32x16_bf16 v[96:111], v[40:43], v[32:35], v[96:111]
    ds_read_b128 v[60:63], v6
    ds_read_b128 v[64:67], v10
    s_add_u32 s31, s51, 20480
    v_mfma_f32_32x32x16_bf16 v[112:127], v[40:43], v[36:39], v[112:127]
    ds_read_b64_tr_b16 v[68:69], v13 offset:2048
    ds_read_b64_tr_b16 v[70:71], v13 offset:2560
    v_dot2c_f32_bf16 v18, v40, v23
    v_dot2c_f32_bf16 v18, v41, v23
    v_dot2c_f32_bf16 v18, v42, v23
    v_dot2c_f32_bf16 v18, v43, v23
    s_waitcnt lgkmcnt(10)
    v_mfma_f32_32x32x16_bf16 v[128:143], v[44:47], v[32:35], v[128:143]
    s_cmp_eq_u32 s31, 102400
    v_mfma_f32_32x32x16_bf16 v[144:159], v[44:47], v[36:39], v[144:159]
    ds_read_b64_tr_b16 v[72:73], v14 offset:4096
    ds_read_b64_tr_b16 v[74:75], v14 offset:5120
    v_dot2c_f32_bf16 v19, v44, v23
    v_dot2c_f32_bf16 v19, v45, v23
    v_dot2c_f32_bf16 v19, v46, v23
    v_dot2c_f32_bf16 v19, v47, v23
    s_waitcnt lgkmcnt(10)
    v_mfma_f32_32x32x16_bf16 v[160:175], v[48:51], v[32:35], v[160:175]
    s_cselect_b32 s31, 0, s31
    v_mfma_f32_32x32x16_bf16 v[176:191], v[48:51], v[36:39], v[176:191]
    ds_read_b64_tr_b16 v[76:77], v15 offset:4096
    ds_read_b64_tr_b16 v[78:79], v15 offset:5120
    v_dot2c_f32_bf16 v20, v48, v23
    v_dot2c_f32_bf16 v20, v49, v23
    v_dot2c_f32_bf16 v20, v50, v23
    v_dot2c_f32_bf16 v20, v51, v23
    s_waitcnt lgkmcnt(10)
    v_mfma_f32_32x32x16_bf16 v[192:207], v[52:55], v[32:35], v[192:207]
    s_sub_u32 s53, s31, s51
    v_mfma_f32_32x32x16_bf16 v[208:223], v[52:55], v[36:39], v[208:223]
    ds_read_b64_tr_b16 v[80:81], v16 offset:4096
    ds_read_b64_tr_b16 v[82:83], v16 offset:5120
    v_dot2c_f32_bf16 v21, v52, v23
    v_dot2c_f32_bf16 v21, v53, v23
    v_dot2c_f32_bf16 v21, v54, v23
    v_dot2c_f32_bf16 v21, v55, v23
    s_waitcnt lgkmcnt(10)
    v_mfma_f32_32x32x16_bf16 v[224:239], v[56:59], v[32:35], v[224:239]
    s_mov_b32 s51, s31
    v_mfma_f32_32x32x16_bf16 v[240:255], v[56:59], v[36:39], v[240:255]
    ds_read_b64_tr_b16 v[84:85], v17 offset:4096
    ds_read_b64_tr_b16 v[86:87], v17 offset:5120
    v_dot2c_f32_bf16 v22, v56, v23
    v_dot2c_f32_bf16 v22, v57, v23
    v_dot2c_f32_bf16 v22, v58, v23
    v_dot2c_f32_bf16 v22, v59, v23
    s_barrier
    s_waitcnt lgkmcnt(8)
    v_mfma_f32_32x32x16_bf16 v[96:111], v[68:71], v[60:63], v[96:111]
    ds_read_b128 v[32:35], v7
    ds_read_b128 v[36:39], v11
    v_mfma_f32_32x32x16_bf16 v[112:127], v[68:71], v[64:67], v[112:127]
    v_add_u32 v13, s53, v13
    ds_read_b64_tr_b16 v[40:41], v13 offset:0
    ds_read_b64_tr_b16 v[42:43], v13 offset:512
    v_dot2c_f32_bf16 v18, v68, v23
    v_dot2c_f32_bf16 v18, v69, v23
    v_dot2c_f32_bf16 v18, v70, v23
    v_dot2c_f32_bf16 v18, v71, v23
    s_waitcnt lgkmcnt(10)
    v_mfma_f32_32x32x16_bf16 v[128:143], v[72:75], v[60:63], v[128:143]
    v_mfma_f32_32x32x16_bf16 v[144:159], v[72:75], v[64:67], v[144:159]
    v_add_u32 v14, s53, v14
    ds_read_b64_tr_b16 v[44:45], v14 offset:0
    ds_read_b64_tr_b16 v[46:47], v14 offset:1024
    v_dot2c_f32_bf16 v19, v72, v23
    v_dot2c_f32_bf16 v19, v73, v23
    v_dot2c_f32_bf16 v19, v74, v23
    v_dot2c_f32_bf16 v19, v75, v23
    s_waitcnt lgkmcnt(10)
    v_mfma_f32_32x32x16_bf16 v[160:175], v[76:79], v[60:63], v[160:175]
    v_mfma_f32_32x32x16_bf16 v[176:191], v[76:79], v[64:67], v[176:191]
    v_add_u32 v15, s53, v15
    ds_read_b64_tr_b16 v[48:49], v15 offset:0
    ds_read_b64_tr_b16 v[50:51], v15 offset:1024
    v_dot2c_f32_bf16 v20, v76, v23
    v_dot2c_f32_bf16 v20, v77, v23
    v_dot2c_f32_bf16 v20, v78, v23
    v_dot2c_f32_bf16 v20, v79, v23
    s_waitcnt lgkmcnt(10)
    v_mfma_f32_32x32x16_bf16 v[192:207], v[80:83], v[60:63], v[192:207]
    v_mfma_f32_32x32x16_bf16 v[208:223], v[80:83], v[64:67], v[208:223]
    v_add_u32 v16, s53, v16
    ds_read_b64_tr_b16 v[52:53], v16 offset:0
    ds_read_b64_tr_b16 v[54:55], v16 offset:1024
    v_dot2c_f32_bf16 v21, v80, v23
    v_dot2c_f32_bf16 v21, v81, v23
    v_dot2c_f32_bf16 v21, v82, v23
    v_dot2c_f32_bf16 v21, v83, v23
    s_waitcnt lgkmcnt(10)
    v_mfma_f32_32x32x16_bf16 v[224:239], v[84:87], v[60:63], v[224:239]
    v_mfma_f32_32x32x16_bf16 v[240:255], v[84:87], v[64:67], v[240:255]
    v_add_u32 v17, s53, v17
    ds_read_b64_tr_b16 v[56:57], v17 offset:0
    ds_read_b64_tr_b16 v[58:59], v17 offset:1024
    v_dot2c_f32_bf16 v22, v84, v23
    v_dot2c_f32_bf16 v22, v85, v23
    v_dot2c_f32_bf16 v22, v86, v23
    v_dot2c_f32_bf16 v22, v87, v23
    s_waitcnt lgkmcnt(8)
    v_mfma_f32_32x32x16_bf16 v[96:111], v[40:43], v[32:35], v[96:111]
    ds_read_b128 v[60:63], v8
    ds_read_b128 v[64:67], v12
    s_add_u32 s31, s51, 20480
    s_cmp_eq_u32 s31, 102400
    v_mfma_f32_32x32x16_bf16 v[112:127], v[40:43], v[36:39], v[112:127]
    ds_read_b64_tr_b16 v[68:69], v13 offset:2048
    ds_read_b64_tr_b16 v[70:71], v13 offset:2560
    v_dot2c_f32_bf16 v18, v40, v23
    v_dot2c_f32_bf16 v18, v41, v23
    v_dot2c_f32_bf16 v18, v42, v23
    v_dot2c_f32_bf16 v18, v43, v23
    s_waitcnt lgkmcnt(10)
    v_mfma_f32_32x32x16_bf16 v[128:143], v[44:47], v[32:35], v[128:143]
    s_cselect_b32 s31, 0, s31
    s_sub_u32 s53, s31, s51
    v_mfma_f32_32x32x16_bf16 v[144:159], v[44:47], v[36:39], v[144:159]
    ds_read_b64_tr_b16 v[72:73], v14 offset:4096
    ds_read_b64_tr_b16 v[74:75], v14 offset:5120
    v_dot2c_f32_bf16 v19, v44, v23
    v_dot2c_f32_bf16 v19, v45, v23
    v_dot2c_f32_bf16 v19, v46, v23
    v_dot2c_f32_bf16 v19, v47, v23
    s_waitcnt lgkmcnt(10)
    v_mfma_f32_32x32x16_bf16 v[160:175], v[48:51], v[32:35], v[160:175]
    s_mov_b32 s51, s31
    s_add_u32 s31, s50, 16384
    v_mfma_f32_32x32x16_bf16 v[176:191], v[48:51], v[36:39], v[176:191]
    ds_read_b64_tr_b16 v[76:77], v15 offset:4096
    ds_read_b64_tr_b16 v[78:79], v15 offset:5120
    v_dot2c_f32_bf16 v20, v48, v23
    v_dot2c_f32_bf16 v20, v49, v23
    v_dot2c_f32_bf16 v20, v50, v23
    v_dot2c_f32_bf16 v20, v51, v23
    s_waitcnt lgkmcnt(10)
    v_mfma_f32_32x32x16_bf16 v[192:207], v[52:55], v[32:35], v[192:207]
    s_cmp_eq_u32 s31, 49152
    s_cselect_b32 s31, 0, s31
    v_mfma_f32_32x32x16_bf16 v[208:223], v[52:55], v[36:39], v[208:223]
    ds_read_b64_tr_b16 v[80:81], v16 offset:4096
    ds_read_b64_tr_b16 v[82:83], v16 offset:5120
    v_dot2c_f32_bf16 v21, v52, v23
    v_dot2c_f32_bf16 v21, v53, v23
    v_dot2c_f32_bf16 v21, v54, v23
    v_dot2c_f32_bf16 v21, v55, v23
    s_waitcnt lgkmcnt(10)
    v_mfma_f32_32x32x16_bf16 v[224:239], v[56:59], v[32:35], v[224:239]
    s_sub_u32 s63, s31, s50
    s_mov_b32 s50, s31
    v_mfma_f32_32x32x16_bf16 v[240:255], v[56:59], v[36:39], v[240:255]
    ds_read_b64_tr_b16 v[84:85], v17 offset:4096
    ds_read_b64_tr_b16 v[86:87], v17 offset:5120
    v_dot2c_f32_bf16 v22, v56, v23
    v_dot2c_f32_bf16 v22, v57, v23
    v_dot2c_f32_bf16 v22, v58, v23
    v_dot2c_f32_bf16 v22, v59, v23
    s_barrier
    s_waitcnt lgkmcnt(8)
    v_mfma_f32_32x32x16_bf16 v[96:111], v[68:71], v[60:63], v[96:111]
    v_add_u32 v5, s63, v5
    v_add_u32 v9, s63, v9
    ds_read_b128 v[32:35], v5
    ds_read_b128 v[36:39], v9
    v_add_u32 v6, s63, v6
    v_mfma_f32_32x32x16_bf16 v[112:127], v[68:71], v[64:67], v[112:127]
    v_add_u32 v13, s53, v13
    ds_read_b64_tr_b16 v[40:41], v13 offset:0
    ds_read_b64_tr_b16 v[42:43], v13 offset:512
    v_dot2c_f32_bf16 v18, v68, v23
    v_dot2c_f32_bf16 v18, v69, v23
    v_dot2c_f32_bf16 v18, v70, v23
    v_dot2c_f32_bf16 v18, v71, v23
    s_waitcnt lgkmcnt(10)
    v_mfma_f32_32x32x16_bf16 v[128:143], v[72:75], v[60:63], v[128:143]
    v_add_u32 v10, s63, v10
    v_add_u32 v7, s63, v7
    v_mfma_f32_32x32x16_bf16 v[144:159], v[72:75], v[64:67], v[144:159]
    v_add_u32 v14, s53, v14
    ds_read_b64_tr_b16 v[44:45], v14 offset:0
    ds_read_b64_tr_b16 v[46:47], v14 offset:1024
    v_dot2c_f32_bf16 v19, v72, v23
    v_dot2c_f32_bf16 v19, v73, v23
    v_dot2c_f32_bf16 v19, v74, v23
    v_dot2c_f32_bf16 v19, v75, v23
    s_waitcnt lgkmcnt(10)
    v_mfma_f32_32x32x16_bf16 v[160:175], v[76:79], v[60:63], v[160:175]
    v_add_u32 v11, s63, v11
    v_mfma_f32_32x32x16_bf16 v[176:191], v[76:79], v[64:67], v[176:191]
    v_add_u32 v15, s53, v15
    ds_read_b64_tr_b16 v[48:49], v15 offset:0
    ds_read_b64_tr_b16 v[50:51], v15 offset:1024
    v_dot2c_f32_bf16 v20, v76, v23
    v_dot2c_f32_bf16 v20, v77, v23
    v_dot2c_f32_bf16 v20, v78, v23
    v_dot2c_f32_bf16 v20, v79, v23
    s_waitcnt lgkmcnt(10)
    v_mfma_f32_32x32x16_bf16 v[192:207], v[80:83], v[60:63], v[192:207]
    v_add_u32 v8, s63, v8
    v_mfma_f32_32x32x16_bf16 v[208:223], v[80:83], v[64:67], v[208:223]
    v_add_u32 v16, s53, v16
    ds_read_b64_tr_b16 v[52:53], v16 offset:0
    ds_read_b64_tr_b16 v[54:55], v16 offset:1024
    v_dot2c_f32_bf16 v21, v80, v23
    v_dot2c_f32_bf16 v21, v81, v23
    v_dot2c_f32_bf16 v21, v82, v23
    v_dot2c_f32_bf16 v21, v83, v23
    s_waitcnt lgkmcnt(10)
    v_mfma_f32_32x32x16_bf16 v[224:239], v[84:87], v[60:63], v[224:239]
    v_add_u32 v12, s63, v12
    v_mfma_f32_32x32x16_bf16 v[240:255], v[84:87], v[64:67], v[240:255]
    v_add_u32 v17, s53, v17
    ds_read_b64_tr_b16 v[56:57], v17 offset:0
    ds_read_b64_tr_b16 v[58:59], v17 offset:1024
    v_dot2c_f32_bf16 v22, v84, v23
    v_dot2c_f32_bf16 v22, v85, v23
    v_dot2c_f32_bf16 v22, v86, v23
    v_dot2c_f32_bf16 v22, v87, v23
    s_nop 2
    v_mov_b32 v26, v18
    v_mov_b32 v27, v19
    v_mov_b32 v28, v20
    v_mov_b32 v29, v21
    v_mov_b32 v30, v22
    s_nop 1
    v_permlane32_swap_b32 v18, v26
    v_permlane32_swap_b32 v19, v27
    v_permlane32_swap_b32 v20, v28
    v_permlane32_swap_b32 v21, v29
    v_permlane32_swap_b32 v22, v30
    s_nop 0
    v_add_f32 v18, v18, v26
    v_add_f32 v19, v19, v27
    v_add_f32 v20, v20, v28
    v_add_f32 v21, v21, v29
    v_add_f32 v22, v22, v30
    s_lshl_b32 s31, s30, 4
    s_add_u32 s31, s31, s29
    s_mul_i32 s31, s31, 1280
    s_mul_i32 s32, s43, 640
    s_add_u32 s31, s31, s32
    s_add_u32 s31, s31, 10485760
    v_lshlrev_b32 v31, 2, v3
    s_mov_b32 exec_hi, 0
    buffer_store_dword v18, v31, s[24:27], s31 offen offset:0 sc1
    buffer_store_dword v19, v31, s[24:27], s31 offen offset:128 sc1
    buffer_store_dword v20, v31, s[24:27], s31 offen offset:256 sc1
    buffer_store_dword v21, v31, s[24:27], s31 offen offset:384 sc1
    buffer_store_dword v22, v31, s[24:27], s31 offen offset:512 sc1
    s_mov_b64 exec, -1
    s_mov_b32 s52, 9
.p2align 3
L_k1_loop0:
    s_cmp_eq_u32 s52, 8
    s_cbranch_scc1 L_k1_signal0
L_k1_signalled0:
    s_waitcnt lgkmcnt(8)
    v_mfma_f32_32x32x16_bf16 v[96:111], v[40:43], v[32:35], v[96:111]
    ds_read_b128 v[60:63], v6
    ds_read_b128 v[64:67], v10
    s_add_u32 s31, s51, 20480
    v_mfma_f32_32x32x16_bf16 v[112:127], v[40:43], v[36:39], v[112:127]
    ds_read_b64_tr_b16 v[68:69], v13 offset:2048
    ds_read_b64_tr_b16 v[70:71], v13 offset:2560
    s_cmp_eq_u32 s31, 102400
    s_waitcnt lgkmcnt(10)
    v_mfma_f32_32x32x16_bf16 v[128:143], v[44:47], v[32:35], v[128:143]
    s_cselect_b32 s31, 0, s31
    v_mfma_f32_32x32x16_bf16 v[144:159], v[44:47], v[36:39], v[144:159]
    ds_read_b64_tr_b16 v[72:73], v14 offset:4096
    ds_read_b64_tr_b16 v[74:75], v14 offset:5120
    s_sub_u32 s53, s31, s51
    s_waitcnt lgkmcnt(10)
    v_mfma_f32_32x32x16_bf16 v[160:175], v[48:51], v[32:35], v[160:175]
    s_mov_b32 s51, s31
    v_mfma_f32_32x32x16_bf16 v[176:191], v[48:51], v[36:39], v[176:191]
    ds_read_b64_tr_b16 v[76:77], v15 offset:4096
    ds_read_b64_tr_b16 v[78:79], v15 offset:5120
    s_waitcnt lgkmcnt(10)
    v_mfma_f32_32x32x16_bf16 v[192:207], v[52:55], v[32:35], v[192:207]
    v_mfma_f32_32x32x16_bf16 v[208:223], v[52:55], v[36:39], v[208:223]
    ds_read_b64_tr_b16 v[80:81], v16 offset:4096
    ds_read_b64_tr_b16 v[82:83], v16 offset:5120
    s_waitcnt lgkmcnt(10)
    v_mfma_f32_32x32x16_bf16 v[224:239], v[56:59], v[32:35], v[224:239]
    v_mfma_f32_32x32x16_bf16 v[240:255], v[56:59], v[36:39], v[240:255]
    ds_read_b64_tr_b16 v[84:85], v17 offset:4096
    ds_read_b64_tr_b16 v[86:87], v17 offset:5120
    s_barrier
    s_waitcnt lgkmcnt(8)
    v_mfma_f32_32x32x16_bf16 v[96:111], v[68:71], v[60:63], v[96:111]
    ds_read_b128 v[32:35], v7
    ds_read_b128 v[36:39], v11
    v_mfma_f32_32x32x16_bf16 v[112:127], v[68:71], v[64:67], v[112:127]
    v_add_u32 v13, s53, v13
    ds_read_b64_tr_b16 v[40:41], v13 offset:0
    ds_read_b64_tr_b16 v[42:43], v13 offset:512
    s_waitcnt lgkmcnt(10)
    v_mfma_f32_32x32x16_bf16 v[128:143], v[72:75], v[60:63], v[128:143]
    v_mfma_f32_32x32x16_bf16 v[144:159], v[72:75], v[64:67], v[144:159]
    v_add_u32 v14, s53, v14
    ds_read_b64_tr_b16 v[44:45], v14 offset:0
    ds_read_b64_tr_b16 v[46:47], v14 offset:1024
    s_waitcnt lgkmcnt(10)
    v_mfma_f32_32x32x16_bf16 v[160:175], v[76:79], v[60:63], v[160:175]
    v_mfma_f32_32x32x16_bf16 v[176:191], v[76:79], v[64:67], v[176:191]
    v_add_u32 v15, s53, v15
    ds_read_b64_tr_b16 v[48:49], v15 offset:0
    ds_read_b64_tr_b16 v[50:51], v15 offset:1024
    s_waitcnt lgkmcnt(10)
    v_mfma_f32_32x32x16_bf16 v[192:207], v[80:83], v[60:63], v[192:207]
    v_mfma_f32_32x32x16_bf16 v[208:223], v[80:83], v[64:67], v[208:223]
    v_add_u32 v16, s53, v16
    ds_read_b64_tr_b16 v[52:53], v16 offset:0
    ds_read_b64_tr_b16 v[54:55], v16 offset:1024
    s_waitcnt lgkmcnt(10)
    v_mfma_f32_32x32x16_bf16 v[224:239], v[84:87], v[60:63], v[224:239]
    v_mfma_f32_32x32x16_bf16 v[240:255], v[84:87], v[64:67], v[240:255]
    v_add_u32 v17, s53, v17
    ds_read_b64_tr_b16 v[56:57], v17 offset:0
    ds_read_b64_tr_b16 v[58:59], v17 offset:1024
    s_waitcnt lgkmcnt(8)
    v_mfma_f32_32x32x16_bf16 v[96:111], v[40:43], v[32:35], v[96:111]
    ds_read_b128 v[60:63], v8
    ds_read_b128 v[64:67], v12
    s_add_u32 s31, s51, 20480
    v_mfma_f32_32x32x16_bf16 v[112:127], v[40:43], v[36:39], v[112:127]
    ds_read_b64_tr_b16 v[68:69], v13 offset:2048
    ds_read_b64_tr_b16 v[70:71], v13 offset:2560
    s_cmp_eq_u32 s31, 102400
    s_waitcnt lgkmcnt(10)
    v_mfma_f32_32x32x16_bf16 v[128:143], v[44:47], v[32:35], v[128:143]
    s_cselect_b32 s31, 0, s31
    v_mfma_f32_32x32x16_bf16 v[144:159], v[44:47], v[36:39], v[144:159]
    ds_read_b64_tr_b16 v[72:73], v14 offset:4096
    ds_read_b64_tr_b16 v[74:75], v14 offset:5120
    s_sub_u32 s53, s31, s51
    s_waitcnt lgkmcnt(10)
    v_mfma_f32_32x32x16_bf16 v[160:175], v[48:51], v[32:35], v[160:175]
    s_mov_b32 s51, s31
    v_mfma_f32_32x32x16_bf16 v[176:191], v[48:51], v[36:39], v[176:191]
    ds_read_b64_tr_b16 v[76:77], v15 offset:4096
    ds_read_b64_tr_b16 v[78:79], v15 offset:5120
    s_add_u32 s31, s50, 16384
    s_waitcnt lgkmcnt(10)
    v_mfma_f32_32x32x16_bf16 v[192:207], v[52:55], v[32:35], v[192:207]
    s_cmp_eq_u32 s31, 49152
    v_mfma_f32_32x32x16_bf16 v[208:223], v[52:55], v[36:39], v[208:223]
    ds_read_b64_tr_b16 v[80:81], v16 offset:4096
    ds_read_b64_tr_b16 v[82:83], v16 offset:5120
    s_cselect_b32 s31, 0, s31
    s_waitcnt lgkmcnt(10)
    v_mfma_f32_32x32x16_bf16 v[224:239], v[56:59], v[32:35], v[224:239]
    s_sub_u32 s63, s31, s50
    v_mfma_f32_32x32x16_bf16 v[240:255], v[56:59], v[36:39], v[240:255]
    ds_read_b64_tr_b16 v[84:85], v17 offset:4096
    ds_read_b64_tr_b16 v[86:87], v17 offset:5120
    s_mov_b32 s50, s31
    s_barrier
    s_waitcnt lgkmcnt(8)
    v_mfma_f32_32x32x16_bf16 v[96:111], v[68:71], v[60:63], v[96:111]
    v_add_u32 v5, s63, v5
    v_add_u32 v9, s63, v9
    ds_read_b128 v[32:35], v5
    ds_read_b128 v[36:39], v9
    v_add_u32 v6, s63, v6
    v_mfma_f32_32x32x16_bf16 v[112:127], v[68:71], v[64:67], v[112:127]
    v_add_u32 v13, s53, v13
    ds_read_b64_tr_b16 v[40:41], v13 offset:0
    ds_read_b64_tr_b16 v[42:43], v13 offset:512
    v_add_u32 v10, s63, v10
    s_waitcnt lgkmcnt(10)
    v_mfma_f32_32x32x16_bf16 v[128:143], v[72:75], v[60:63], v[128:143]
    v_add_u32 v7, s63, v7
    v_mfma_f32_32x32x16_bf16 v[144:159], v[72:75], v[64:67], v[144:159]
    v_add_u32 v14, s53, v14
    ds_read_b64_tr_b16 v[44:45], v14 offset:0
    ds_read_b64_tr_b16 v[46:47], v14 offset:1024
    v_add_u32 v11, s63, v11
    s_waitcnt lgkmcnt(10)
    v_mfma_f32_32x32x16_bf16 v[160:175], v[76:79], v[60:63], v[160:175]
    v_add_u32 v8, s63, v8
    v_mfma_f32_32x32x16_bf16 v[176:191], v[76:79], v[64:67], v[176:191]
    v_add_u32 v15, s53, v15
    ds_read_b64_tr_b16 v[48:49], v15 offset:0
    ds_read_b64_tr_b16 v[50:51], v15 offset:1024
    v_add_u32 v12, s63, v12
    s_waitcnt lgkmcnt(10)
    v_mfma_f32_32x32x16_bf16 v[192:207], v[80:83], v[60:63], v[192:207]
    v_mfma_f32_32x32x16_bf16 v[208:223], v[80:83], v[64:67], v[208:223]
    v_add_u32 v16, s53, v16
    ds_read_b64_tr_b16 v[52:53], v16 offset:0
    ds_read_b64_tr_b16 v[54:55], v16 offset:1024
    s_waitcnt lgkmcnt(10)
    v_mfma_f32_32x32x16_bf16 v[224:239], v[84:87], v[60:63], v[224:239]
    v_mfma_f32_32x32x16_bf16 v[240:255], v[84:87], v[64:67], v[240:255]
    v_add_u32 v17, s53, v17
    ds_read_b64_tr_b16 v[56:57], v17 offset:0
    ds_read_b64_tr_b16 v[58:59], v17 offset:1024
    s_sub_u32 s52, s52, 1
    s_cmp_lg_u32 s52, 0
    s_cbranch_scc1 L_k1_loop0
    s_branch L_k1_post
L_k1_signal0:
    s_waitcnt vmcnt(0)
    v_mov_b32 v26, 153856
    v_mov_b32 v27, 1
    s_mov_b64 exec, 1
    ds_add_rtn_u32 v28, v26, v27
    s_waitcnt lgkmcnt(0)
    v_readfirstlane_b32 s31, v28
    v_mov_b32 v26, 0
    s_cmp_lg_u32 s31, 3
    s_cbranch_scc1 L_k1_nosig0
    global_atomic_add v26, v27, s[66:67]
L_k1_nosig0:
    s_mov_b64 exec, -1
    s_branch L_k1_signalled0
L_k1_main1:
    v_bfe_u32 v26, v2, 2, 2
    v_lshrrev_b32 v27, 5, v2
    v_lshl_add_u32 v27, v27, 3, v26
    v_bfe_u32 v28, v2, 4, 1
    v_lshlrev_b32 v28, 5, v28
    v_and_b32 v29, 3, v2
    v_lshl_add_u32 v28, v29, 3, v28
    s_mul_i32 s64, s43, 3
    s_add_u32 s64, s64, 0
    v_lshrrev_b32 v29, 1, v26
    v_xor_b32 v29, s64, v29
    v_lshl_add_u32 v29, v29, 6, v28
    v_mul_u32_u24 v13, 384, v27
    v_add_u32 v13, v13, v29
    v_add_u32 v13, 49152, v13
    s_mul_i32 s64, s43, 3
    s_add_u32 s64, s64, 1
    v_lshrrev_b32 v29, 1, v26
    v_xor_b32 v29, s64, v29
    v_lshl_add_u32 v29, v29, 6, v28
    v_mul_u32_u24 v14, 384, v27
    v_add_u32 v14, v14, v29
    v_add_u32 v14, 49152, v14
    s_mul_i32 s64, s43, 3
    s_add_u32 s64, s64, 2
    v_lshrrev_b32 v29, 1, v26
    v_xor_b32 v29, s64, v29
    v_lshl_add_u32 v29, v29, 6, v28
    v_mul_u32_u24 v15, 384, v27
    v_add_u32 v15, v15, v29
    v_add_u32 v15, 49152, v15
    s_mul_i32 s64, s43, 1
    s_add_u32 s64, s64, 0
    v_lshrrev_b32 v29, 1, v26
    v_xor_b32 v29, s64, v29
    v_lshl_add_u32 v29, v29, 6, v28
    v_mul_u32_u24 v16, 128, v27
    v_add_u32 v16, v16, v29
    v_add_u32 v16, 61440, v16
    s_mul_i32 s64, s43, 1
    s_add_u32 s64, s64, 0
    v_lshrrev_b32 v29, 1, v26
    v_xor_b32 v29, s64, v29
    v_lshl_add_u32 v29, v29, 6, v28
    v_mul_u32_u24 v17, 128, v27
    v_add_u32 v17, v17, v29
    v_add_u32 v17, 65536, v17
    s_getpc_b64 s[46:47]
L_pc_k1_1:
    s_add_u32 s46, s46, L_k1_loop1-L_pc_k1_1
    s_addc_u32 s47, s47, 0
    v_lshlrev_b32 v92, 4, v2
    global_load_dwordx4 v[88:91], v92, s[46:47]
    v_add_u32 v92, 1024, v92
    global_load_dwordx4 v[88:91], v92, s[46:47]
    v_add_u32 v92, 1024, v92
    global_load_dwordx4 v[88:91], v92, s[46:47]
    v_add_u32 v92, 1024, v92
    global_load_dwordx4 v[88:91], v92, s[46:47]
    s_getpc_b64 s[46:47]
L_pc_k1_1e:
    s_add_u32 s46, s46, L_k1_post-L_pc_k1_1e
    s_addc_u32 s47, s47, 0
    v_lshlrev_b32 v92, 4, v2
    global_load_dwordx4 v[88:91], v92, s[46:47]
    v_add_u32 v92, 1024, v92
    global_load_dwordx4 v[88:91], v92, s[46:47]
    v_add_u32 v92, 1024, v92
    global_load_dwordx4 v[88:91], v92, s[46:47]
    v_add_u32 v92, 1024, v92
    global_load_dwordx4 v[88:91], v92, s[46:47]
    v_add_u32 v92, 1024, v92
    global_load_dwordx4 v[88:91], v92, s[46:47]
    v_add_u32 v92, 1024, v92
    global_load_dwordx4 v[88:91], v92, s[46:47]
    v_add_u32 v92, 1024, v92
    global_load_dwordx4 v[88:91], v92, s[46:47]
    v_add_u32 v92, 1024, v92
    global_load_dwordx4 v[88:91], v92, s[46:47]
    s_cmp_eq_u32 s42, 0
    s_cbranch_scc1 L_k1_sjd1
    s_waitcnt vmcnt(0)
    v_lshlrev_b32 v122, 16, v96
    v_and_b32 v123, 0xffff0000, v96
    v_add_f32 v120, v122, v123
    v_mul_f32 v121, v122, v122
    v_fmac_f32 v121, v123, v123
    v_lshlrev_b32 v124, 16, v97
    v_and_b32 v125, 0xffff0000, v97
    v_add_f32 v120, v120, v124
    v_fmac_f32 v121, v124, v124
    v_add_f32 v120, v120, v125
    v_fmac_f32 v121, v125, v125
    v_lshlrev_b32 v122, 16, v98
    v_and_b32 v123, 0xffff0000, v98
    v_add_f32 v120, v120, v122
    v_fmac_f32 v121, v122, v122
    v_add_f32 v120, v120, v123
    v_fmac_f32 v121, v123, v123
    v_lshlrev_b32 v124, 16, v99
    v_and_b32 v125, 0xffff0000, v99
    v_add_f32 v120, v120, v124
    v_fmac_f32 v121, v124, v124
    v_add_f32 v120, v120, v125
    v_fmac_f32 v121, v125, v125
    v_lshlrev_b32 v122, 16, v100
    v_and_b32 v123, 0xffff0000, v100
    v_add_f32 v120, v120, v122
    v_fmac_f32 v121, v122, v122
    v_add_f32 v120, v120, v123
    v_fmac_f32 v121, v123, v123
    v_lshlrev_b32 v124, 16, v101
    v_and_b32 v125, 0xffff0000, v101
    v_add_f32 v120, v120, v124
    v_fmac_f32 v121, v124, v124
    v_add_f32 v120, v120, v125
    v_fmac_f32 v121, v125, v125
    v_lshlrev_b32 v122, 16, v102
    v_and_b32 v123, 0xffff0000, v102
    v_add_f32 v120, v120, v122
    v_fmac_f32 v121, v122, v122
    v_add_f32 v120, v120, v123
    v_fmac_f32 v121, v123, v123
    v_lshlrev_b32 v124, 16, v103
    v_and_b32 v125, 0xffff0000, v103
    v_add_f32 v120, v120, v124
    v_fmac_f32 v121, v124, v124
    v_add_f32 v120, v120, v125
    v_fmac_f32 v121, v125, v125
    v_lshlrev_b32 v122, 16, v104
    v_and_b32 v123, 0xffff0000, v104
    v_add_f32 v120, v120, v122
    v_fmac_f32 v121, v122, v122
    v_add_f32 v120, v120, v123
    v_fmac_f32 v121, v123, v123
    v_lshlrev_b32 v124, 16, v105
    v_and_b32 v125, 0xffff0000, v105
    v_add_f32 v120, v120, v124
    v_fmac_f32 v121, v124, v124
    v_add_f32 v120, v120, v125
    v_fmac_f32 v121, v125, v125
    v_lshlrev_b32 v122, 16, v106
    v_and_b32 v123, 0xffff0000, v106
    v_add_f32 v120, v120, v122
    v_fmac_f32 v121, v122, v122
    v_add_f32 v120, v120, v123
    v_fmac_f32 v121, v123, v123
    v_lshlrev_b32 v124, 16, v107
    v_and_b32 v125, 0xffff0000, v107
    v_add_f32 v120, v120, v124
    v_fmac_f32 v121, v124, v124
    v_add_f32 v120, v120, v125
    v_fmac_f32 v121, v125, v125
    s_nop 1
    v_add_f32_dpp v120, v120, v120 row_ror:8 row_mask:0xf bank_mask:0xf
    v_add_f32_dpp v121, v121, v121 row_ror:8 row_mask:0xf bank_mask:0xf
    s_nop 1
    v_add_f32_dpp v120, v120, v120 row_ror:4 row_mask:0xf bank_mask:0xf
    v_add_f32_dpp v121, v121, v121 row_ror:4 row_mask:0xf bank_mask:0xf
    s_nop 1
    v_add_f32_dpp v120, v120, v120 row_ror:2 row_mask:0xf bank_mask:0xf
    v_add_f32_dpp v121, v121, v121 row_ror:2 row_mask:0xf bank_mask:0xf
    s_nop 1
    v_add_f32_dpp v120, v120, v120 row_ror:1 row_mask:0xf bank_mask:0xf
    v_add_f32_dpp v121, v121, v121 row_ror:1 row_mask:0xf bank_mask:0xf
    v_mov_b32 v122, v120
    v_mov_b32 v123, v121
    s_nop 1
    v_permlane16_swap_b32 v122, v120
    v_permlane16_swap_b32 v123, v121
    s_nop 0
    v_add_f32 v120, v120, v122
    v_add_f32 v121, v121, v123
    v_mul_f32 v126, 0x3acccccd, v120
    v_mul_f32 v121, 0x3acccccd, v121
    v_fma_f32 v121, -v126, v126, v121
    v_max_f32 v121, 0, v121
    v_add_f32 v121, 0x3727c5ac, v121
    v_rsq_f32 v127, v121
    v_lshlrev_b32 v122, 16, v108
    v_and_b32 v123, 0xffff0000, v108
    v_add_f32 v120, v122, v123
    v_mul_f32 v121, v122, v122
    v_fmac_f32 v121, v123, v123
    v_lshlrev_b32 v124, 16, v109
    v_and_b32 v125, 0xffff0000, v109
    v_add_f32 v120, v120, v124
    v_fmac_f32 v121, v124, v124
    v_add_f32 v120, v120, v125
    v_fmac_f32 v121, v125, v125
    v_lshlrev_b32 v122, 16, v110
    v_and_b32 v123, 0xffff0000, v110
    v_add_f32 v120, v120, v122
    v_fmac_f32 v121, v122, v122
    v_add_f32 v120, v120, v123
    v_fmac_f32 v121, v123, v123
    v_lshlrev_b32 v124, 16, v111
    v_and_b32 v125, 0xffff0000, v111
    v_add_f32 v120, v120, v124
    v_fmac_f32 v121, v124, v124
    v_add_f32 v120, v120, v125
    v_fmac_f32 v121, v125, v125
    v_lshlrev_b32 v122, 16, v112
    v_and_b32 v123, 0xffff0000, v112
    v_add_f32 v120, v120, v122
    v_fmac_f32 v121, v122, v122
    v_add_f32 v120, v120, v123
    v_fmac_f32 v121, v123, v123
    v_lshlrev_b32 v124, 16, v113
    v_and_b32 v125, 0xffff0000, v113
    v_add_f32 v120, v120, v124
    v_fmac_f32 v121, v124, v124
    v_add_f32 v120, v120, v125
    v_fmac_f32 v121, v125, v125
    v_lshlrev_b32 v122, 16, v114
    v_and_b32 v123, 0xffff0000, v114
    v_add_f32 v120, v120, v122
    v_fmac_f32 v121, v122, v122
    v_add_f32 v120, v120, v123
    v_fmac_f32 v121, v123, v123
    v_lshlrev_b32 v124, 16, v115
    v_and_b32 v125, 0xffff0000, v115
    v_add_f32 v120, v120, v124
    v_fmac_f32 v121, v124, v124
    v_add_f32 v120, v120, v125
    v_fmac_f32 v121, v125, v125
    v_lshlrev_b32 v122, 16, v116
    v_and_b32 v123, 0xffff0000, v116
    v_add_f32 v120, v120, v122
    v_fmac_f32 v121, v122, v122
    v_add_f32 v120, v120, v123
    v_fmac_f32 v121, v123, v123
    v_lshlrev_b32 v124, 16, v117
    v_and_b32 v125, 0xffff0000, v117
    v_add_f32 v120, v120, v124
    v_fmac_f32 v121, v124, v124
    v_add_f32 v120, v120, v125
    v_fmac_f32 v121, v125, v125
    v_lshlrev_b32 v122, 16, v118
    v_and_b32 v123, 0xffff0000, v118
    v_add_f32 v120, v120, v122
    v_fmac_f32 v121, v122, v122
    v_add_f32 v120, v120, v123
    v_fmac_f32 v121, v123, v123
    v_lshlrev_b32 v124, 16, v119
    v_and_b32 v125, 0xffff0000, v119
    v_add_f32 v120, v120, v124
    v_fmac_f32 v121, v124, v124
    v_add_f32 v120, v120, v125
    v_fmac_f32 v121, v125, v125
    s_nop 1
    v_add_f32_dpp v120, v120, v120 row_ror:8 row_mask:0xf bank_mask:0xf
    v_add_f32_dpp v121, v121, v121 row_ror:8 row_mask:0xf bank_mask:0xf
    s_nop 1
    v_add_f32_dpp v120, v120, v120 row_ror:4 row_mask:0xf bank_mask:0xf
    v_add_f32_dpp v121, v121, v121 row_ror:4 row_mask:0xf bank_mask:0xf
    s_nop 1
    v_add_f32_dpp v120, v120, v120 row_ror:2 row_mask:0xf bank_mask:0xf
    v_add_f32_dpp v121, v121, v121 row_ror:2 row_mask:0xf bank_mask:0xf
    s_nop 1
    v_add_f32_dpp v120, v120, v120 row_ror:1 row_mask:0xf bank_mask:0xf
    v_add_f32_dpp v121, v121, v121 row_ror:1 row_mask:0xf bank_mask:0xf
    v_mov_b32 v122, v120
    v_mov_b32 v123, v121
    s_nop 1
    v_permlane16_swap_b32 v122, v120
    v_permlane16_swap_b32 v123, v121
    s_nop 0
    v_add_f32 v120, v120, v122
    v_add_f32 v121, v121, v123
    v_mul_f32 v128, 0x3acccccd, v120
    v_mul_f32 v121, 0x3acccccd, v121
    v_fma_f32 v121, -v128, v128, v121
    v_max_f32 v121, 0, v121
    v_add_f32 v121, 0x3727c5ac, v121
    v_rsq_f32 v129, v121
    v_lshlrev_b32 v26, 3, v4
    s_lshl_b32 s31, s34, 3
    s_add_u32 s31, s31, 11010048
    v_cmp_eq_u32 vcc, 0, v3
    s_nop 0
    s_and_saveexec_b64 s[68:69], vcc
    buffer_store_dwordx2 v[126:127], v26, s[24:27], s31 offen offset:0 sc1
    buffer_store_dwordx2 v[128:129], v26, s[24:27], s31 offen offset:16 sc1
    s_mov_b64 exec, -1
L_k1_sjd1:
    v_mov_b32 v96, 0
    v_mov_b32 v97, 0
    v_mov_b32 v98, 0
    v_mov_b32 v99, 0
    v_mov_b32 v100, 0
    v_mov_b32 v101, 0
    v_mov_b32 v102, 0
    v_mov_b32 v103, 0
    v_mov_b32 v104, 0
    v_mov_b32 v105, 0
    v_mov_b32 v106, 0
    v_mov_b32 v107, 0
    v_mov_b32 v108, 0
    v_mov_b32 v109, 0
    v_mov_b32 v110, 0
    v_mov_b32 v111, 0
    v_mov_b32 v112, 0
    v_mov_b32 v113, 0
    v_mov_b32 v114, 0
    v_mov_b32 v115, 0
    v_mov_b32 v116, 0
    v_mov_b32 v117, 0
    v_mov_b32 v118, 0
    v_mov_b32 v119, 0
    v_mov_b32 v120, 0
    v_mov_b32 v121, 0
    v_mov_b32 v122, 0
    v_mov_b32 v123, 0
    v_mov_b32 v124, 0
    v_mov_b32 v125, 0
    v_mov_b32 v126, 0
    v_mov_b32 v127, 0
    v_mov_b32 v128, 0
    v_mov_b32 v129, 0
    v_mov_b32 v130, 0
    v_mov_b32 v131, 0
    v_mov_b32 v132, 0
    v_mov_b32 v133, 0
    v_mov_b32 v134, 0
    v_mov_b32 v135, 0
    v_mov_b32 v136, 0
    v_mov_b32 v137, 0
    v_mov_b32 v138, 0
    v_mov_b32 v139, 0
    v_mov_b32 v140, 0
    v_mov_b32 v141, 0
    v_mov_b32 v142, 0
    v_mov_b32 v143, 0
    v_mov_b32 v144, 0
    v_mov_b32 v145, 0
    v_mov_b32 v146, 0
    v_mov_b32 v147, 0
    v_mov_b32 v148, 0
    v_mov_b32 v149, 0
    v_mov_b32 v150, 0
    v_mov_b32 v151, 0
    v_mov_b32 v152, 0
    v_mov_b32 v153, 0
    v_mov_b32 v154, 0
    v_mov_b32 v155, 0
    v_mov_b32 v156, 0
    v_mov_b32 v157, 0
    v_mov_b32 v158, 0
    v_mov_b32 v159, 0
    v_mov_b32 v160, 0
    v_mov_b32 v161, 0
    v_mov_b32 v162, 0
    v_mov_b32 v163, 0
    v_mov_b32 v164, 0
    v_mov_b32 v165, 0
    v_mov_b32 v166, 0
    v_mov_b32 v167, 0
    v_mov_b32 v168, 0
    v_mov_b32 v169, 0
    v_mov_b32 v170, 0
    v_mov_b32 v171, 0
    v_mov_b32 v172, 0
    v_mov_b32 v173, 0
    v_mov_b32 v174, 0
    v_mov_b32 v175, 0
    v_mov_b32 v176, 0
    v_mov_b32 v177, 0
    v_mov_b32 v178, 0
    v_mov_b32 v179, 0
    v_mov_b32 v180, 0
    v_mov_b32 v181, 0
    v_mov_b32 v182, 0
    v_mov_b32 v183, 0
    v_mov_b32 v184, 0
    v_mov_b32 v185, 0
    v_mov_b32 v186, 0
    v_mov_b32 v187, 0
    v_mov_b32 v188, 0
    v_mov_b32 v189, 0
    v_mov_b32 v190, 0
    v_mov_b32 v191, 0
    v_mov_b32 v192, 0
    v_mov_b32 v193, 0
    v_mov_b32 v194, 0
    v_mov_b32 v195, 0
    v_mov_b32 v196, 0
    v_mov_b32 v197, 0
    v_mov_b32 v198, 0
    v_mov_b32 v199, 0
    v_mov_b32 v200, 0
    v_mov_b32 v201, 0
    v_mov_b32 v202, 0
    v_mov_b32 v203, 0
    v_mov_b32 v204, 0
    v_mov_b32 v205, 0
    v_mov_b32 v206, 0
    v_mov_b32 v207, 0
    v_mov_b32 v208, 0
    v_mov_b32 v209, 0
    v_mov_b32 v210, 0
    v_mov_b32 v211, 0
    v_mov_b32 v212, 0
    v_mov_b32 v213, 0
    v_mov_b32 v214, 0
    v_mov_b32 v215, 0
    v_mov_b32 v216, 0
    v_mov_b32 v217, 0
    v_mov_b32 v218, 0
    v_mov_b32 v219, 0
    v_mov_b32 v220, 0
    v_mov_b32 v221, 0
    v_mov_b32 v222, 0
    v_mov_b32 v223, 0
    v_mov_b32 v224, 0
    v_mov_b32 v225, 0
    v_mov_b32 v226, 0
    v_mov_b32 v227, 0
    v_mov_b32 v228, 0
    v_mov_b32 v229, 0
    v_mov_b32 v230, 0
    v_mov_b32 v231, 0
    v_mov_b32 v232, 0
    v_mov_b32 v233, 0
    v_mov_b32 v234, 0
    v_mov_b32 v235, 0
    v_mov_b32 v236, 0
    v_mov_b32 v237, 0
    v_mov_b32 v238, 0
    v_mov_b32 v239, 0
    v_mov_b32 v240, 0
    v_mov_b32 v241, 0
    v_mov_b32 v242, 0
    v_mov_b32 v243, 0
    v_mov_b32 v244, 0
    v_mov_b32 v245, 0
    v_mov_b32 v246, 0
    v_mov_b32 v247, 0
    v_mov_b32 v248, 0
    v_mov_b32 v249, 0
    v_mov_b32 v250, 0
    v_mov_b32 v251, 0
    v_mov_b32 v252, 0
    v_mov_b32 v253, 0
    v_mov_b32 v254, 0
    v_mov_b32 v255, 0
    s_barrier
    ds_read_b128 v[32:35], v5
    ds_read_b128 v[36:39], v9
    ds_read_b64_tr_b16 v[40:41], v13 offset:0
    ds_read_b64_tr_b16 v[42:43], v13 offset:1536
    ds_read_b64_tr_b16 v[44:45], v14 offset:0
    ds_read_b64_tr_b16 v[46:47], v14 offset:1536
    ds_read_b64_tr_b16 v[48:49], v15 offset:0
    ds_read_b64_tr_b16 v[50:51], v15 offset:1536
    ds_read_b64_tr_b16 v[52:53], v16 offset:0
    ds_read_b64_tr_b16 v[54:55], v16 offset:512
    ds_read_b64_tr_b16 v[56:57], v17 offset:0
    ds_read_b64_tr_b16 v[58:59], v17 offset:512
    s_mov_b32 s50, 0
    s_mov_b32 s51, 0
    s_mov_b32 s52, 10
    s_cmp_lt_u32 s29, 10
    s_cselect_b32 s31, 0, 1
    s_or_b32 s31, s31, s42
    s_cmp_lg_u32 s31, 0
    s_cbranch_scc1 L_k1_loop1
    v_mov_b32 v18, 0
    v_mov_b32 v19, 0
    v_mov_b32 v20, 0
    v_mov_b32 v21, 0
    v_mov_b32 v22, 0
    v_mov_b32 v23, 0x3f803f80
    s_nop 0
    s_waitcnt lgkmcnt(8)
    v_mfma_f32_32x32x16_bf16 v[96:111], v[40:43], v[32:35], v[96:111]
    ds_read_b128 v[60:63], v6
    ds_read_b128 v[64:67], v10
    s_add_u32 s31, s51, 20480
    v_mfma_f32_32x32x16_bf16 v[112:127], v[40:43], v[36:39], v[112:127]
    ds_read_b64_tr_b16 v[68:69], v13 offset:6144
    ds_read_b64_tr_b16 v[70:71], v13 offset:7680
    v_dot2c_f32_bf16 v18, v40, v23
    v_dot2c_f32_bf16 v18, v41, v23
    v_dot2c_f32_bf16 v18, v42, v23
    v_dot2c_f32_bf16 v18, v43, v23
    s_waitcnt lgkmcnt(10)
    v_mfma_f32_32x32x16_bf16 v[128:143], v[44:47], v[32:35], v[128:143]
    s_cmp_eq_u32 s31, 102400
    v_mfma_f32_32x32x16_bf16 v[144:159], v[44:47], v[36:39], v[144:159]
    ds_read_b64_tr_b16 v[72:73], v14 offset:6144
    ds_read_b64_tr_b16 v[74:75], v14 offset:7680
    v_dot2c_f32_bf16 v19, v44, v23
    v_dot2c_f32_bf16 v19, v45, v23
    v_dot2c_f32_bf16 v19, v46, v23
    v_dot2c_f32_bf16 v19, v47, v23
    s_waitcnt lgkmcnt(10)
    v_mfma_f32_32x32x16_bf16 v[160:175], v[48:51], v[32:35], v[160:175]
    s_cselect_b32 s31, 0, s31
    v_mfma_f32_32x32x16_bf16 v[176:191], v[48:51], v[36:39], v[176:191]
    ds_read_b64_tr_b16 v[76:77], v15 offset:6144
    ds_read_b64_tr_b16 v[78:79], v15 offset:7680
    v_dot2c_f32_bf16 v20, v48, v23
    v_dot2c_f32_bf16 v20, v49, v23
    v_dot2c_f32_bf16 v20, v50, v23
    v_dot2c_f32_bf16 v20, v51, v23
    s_waitcnt lgkmcnt(10)
    v_mfma_f32_32x32x16_bf16 v[192:207], v[52:55], v[32:35], v[192:207]
    s_sub_u32 s53, s31, s51
    v_mfma_f32_32x32x16_bf16 v[208:223], v[52:55], v[36:39], v[208:223]
    ds_read_b64_tr_b16 v[80:81], v16 offset:2048
    ds_read_b64_tr_b16 v[82:83], v16 offset:2560
    v_dot2c_f32_bf16 v21, v52, v23
    v_dot2c_f32_bf16 v21, v53, v23
    v_dot2c_f32_bf16 v21, v54, v23
    v_dot2c_f32_bf16 v21, v55, v23
    s_waitcnt lgkmcnt(10)
    v_mfma_f32_32x32x16_bf16 v[224:239], v[56:59], v[32:35], v[224:239]
    s_mov_b32 s51, s31
    v_mfma_f32_32x32x16_bf16 v[240:255], v[56:59], v[36:39], v[240:255]
    ds_read_b64_tr_b16 v[84:85], v17 offset:2048
    ds_read_b64_tr_b16 v[86:87], v17 offset:2560
    v_dot2c_f32_bf16 v22, v56, v23
    v_dot2c_f32_bf16 v22, v57, v23
    v_dot2c_f32_bf16 v22, v58, v23
    v_dot2c_f32_bf16 v22, v59, v23
    s_barrier
    s_waitcnt lgkmcnt(8)
    v_mfma_f32_32x32x16_bf16 v[96:111], v[68:71], v[60:63], v[96:111]
    ds_read_b128 v[32:35], v7
    ds_read_b128 v[36:39], v11
    v_mfma_f32_32x32x16_bf16 v[112:127], v[68:71], v[64:67], v[112:127]
    v_add_u32 v13, s53, v13
    ds_read_b64_tr_b16 v[40:41], v13 offset:0
    ds_read_b64_tr_b16 v[42:43], v13 offset:1536
    v_dot2c_f32_bf16 v18, v68, v23
    v_dot2c_f32_bf16 v18, v69, v23
    v_dot2c_f32_bf16 v18, v70, v23
    v_dot2c_f32_bf16 v18, v71, v23
    s_waitcnt lgkmcnt(10)
    v_mfma_f32_32x32x16_bf16 v[128:143], v[72:75], v[60:63], v[128:143]
    v_mfma_f32_32x32x16_bf16 v[144:159], v[72:75], v[64:67], v[144:159]
    v_add_u32 v14, s53, v14
    ds_read_b64_tr_b16 v[44:45], v14 offset:0
    ds_read_b64_tr_b16 v[46:47], v14 offset:1536
    v_dot2c_f32_bf16 v19, v72, v23
    v_dot2c_f32_bf16 v19, v73, v23
    v_dot2c_f32_bf16 v19, v74, v23
    v_dot2c_f32_bf16 v19, v75, v23
    s_waitcnt lgkmcnt(10)
    v_mfma_f32_32x32x16_bf16 v[160:175], v[76:79], v[60:63], v[160:175]
    v_mfma_f32_32x32x16_bf16 v[176:191], v[76:79], v[64:67], v[176:191]
    v_add_u32 v15, s53, v15
    ds_read_b64_tr_b16 v[48:49], v15 offset:0
    ds_read_b64_tr_b16 v[50:51], v15 offset:1536
    v_dot2c_f32_bf16 v20, v76, v23
    v_dot2c_f32_bf16 v20, v77, v23
    v_dot2c_f32_bf16 v20, v78, v23
    v_dot2c_f32_bf16 v20, v79, v23
    s_waitcnt lgkmcnt(10)
    v_mfma_f32_32x32x16_bf16 v[192:207], v[80:83], v[60:63], v[192:207]
    v_mfma_f32_32x32x16_bf16 v[208:223], v[80:83], v[64:67], v[208:223]
    v_add_u32 v16, s53, v16
    ds_read_b64_tr_b16 v[52:53], v16 offset:0
    ds_read_b64_tr_b16 v[54:55], v16 offset:512
    v_dot2c_f32_bf16 v21, v80, v23
    v_dot2c_f32_bf16 v21, v81, v23
    v_dot2c_f32_bf16 v21, v82, v23
    v_dot2c_f32_bf16 v21, v83, v23
    s_waitcnt lgkmcnt(10)
    v_mfma_f32_32x32x16_bf16 v[224:239], v[84:87], v[60:63], v[224:239]
    v_mfma_f32_32x32x16_bf16 v[240:255], v[84:87], v[64:67], v[240:255]
    v_add_u32 v17, s53, v17
    ds_read_b64_tr_b16 v[56:57], v17 offset:0
    ds_read_b64_tr_b16 v[58:59], v17 offset:512
    v_dot2c_f32_bf16 v22, v84, v23
    v_dot2c_f32_bf16 v22, v85, v23
    v_dot2c_f32_bf16 v22, v86, v23
    v_dot2c_f32_bf16 v22, v87, v23
    s_waitcnt lgkmcnt(8)
    v_mfma_f32_32x32x16_bf16 v[96:111], v[40:43], v[32:35], v[96:111]
    ds_read_b128 v[60:63], v8
    ds_read_b128 v[64:67], v12
    s_add_u32 s31, s51, 20480
    s_cmp_eq_u32 s31, 102400
    v_mfma_f32_32x32x16_bf16 v[112:127], v[40:43], v[36:39], v[112:127]
    ds_read_b64_tr_b16 v[68:69], v13 offset:6144
    ds_read_b64_tr_b16 v[70:71], v13 offset:7680
    v_dot2c_f32_bf16 v18, v40, v23
    v_dot2c_f32_bf16 v18, v41, v23
    v_dot2c_f32_bf16 v18, v42, v23
    v_dot2c_f32_bf16 v18, v43, v23
    s_waitcnt lgkmcnt(10)
    v_mfma_f32_32x32x16_bf16 v[128:143], v[44:47], v[32:35], v[128:143]
    s_cselect_b32 s31, 0, s31
    s_sub_u32 s53, s31, s51
    v_mfma_f32_32x32x16_bf16 v[144:159], v[44:47], v[36:39], v[144:159]
    ds_read_b64_tr_b16 v[72:73], v14 offset:6144
    ds_read_b64_tr_b16 v[74:75], v14 offset:7680
    v_dot2c_f32_bf16 v19, v44, v23
    v_dot2c_f32_bf16 v19, v45, v23
    v_dot2c_f32_bf16 v19, v46, v23
    v_dot2c_f32_bf16 v19, v47, v23
    s_waitcnt lgkmcnt(10)
    v_mfma_f32_32x32x16_bf16 v[160:175], v[48:51], v[32:35], v[160:175]
    s_mov_b32 s51, s31
    s_add_u32 s31, s50, 16384
    v_mfma_f32_32x32x16_bf16 v[176:191], v[48:51], v[36:39], v[176:191]
    ds_read_b64_tr_b16 v[76:77], v15 offset:6144
    ds_read_b64_tr_b16 v[78:79], v15 offset:7680
    v_dot2c_f32_bf16 v20, v48, v23
    v_dot2c_f32_bf16 v20, v49, v23
    v_dot2c_f32_bf16 v20, v50, v23
    v_dot2c_f32_bf16 v20, v51, v23
    s_waitcnt lgkmcnt(10)
    v_mfma_f32_32x32x16_bf16 v[192:207], v[52:55], v[32:35], v[192:207]
    s_cmp_eq_u32 s31, 49152
    s_cselect_b32 s31, 0, s31
    v_mfma_f32_32x32x16_bf16 v[208:223], v[52:55], v[36:39], v[208:223]
    ds_read_b64_tr_b16 v[80:81], v16 offset:2048
    ds_read_b64_tr_b16 v[82:83], v16 offset:2560
    v_dot2c_f32_bf16 v21, v52, v23
    v_dot2c_f32_bf16 v21, v53, v23
    v_dot2c_f32_bf16 v21, v54, v23
    v_dot2c_f32_bf16 v21, v55, v23
    s_waitcnt lgkmcnt(10)
    v_mfma_f32_32x32x16_bf16 v[224:239], v[56:59], v[32:35], v[224:239]
    s_sub_u32 s63, s31, s50
    s_mov_b32 s50, s31
    v_mfma_f32_32x32x16_bf16 v[240:255], v[56:59], v[36:39], v[240:255]
    ds_read_b64_tr_b16 v[84:85], v17 offset:2048
    ds_read_b64_tr_b16 v[86:87], v17 offset:2560
    v_dot2c_f32_bf16 v22, v56, v23
    v_dot2c_f32_bf16 v22, v57, v23
    v_dot2c_f32_bf16 v22, v58, v23
    v_dot2c_f32_bf16 v22, v59, v23
    s_barrier
    s_waitcnt lgkmcnt(8)
    v_mfma_f32_32x32x16_bf16 v[96:111], v[68:71], v[60:63], v[96:111]
    v_add_u32 v5, s63, v5
    v_add_u32 v9, s63, v9
    ds_read_b128 v[32:35], v5
    ds_read_b128 v[36:39], v9
    v_add_u32 v6, s63, v6
    v_mfma_f32_32x32x16_bf16 v[112:127], v[68:71], v[64:67], v[112:127]
    v_add_u32 v13, s53, v13
    ds_read_b64_tr_b16 v[40:41], v13 offset:0
    ds_read_b64_tr_b16 v[42:43], v13 offset:1536
    v_dot2c_f32_bf16 v18, v68, v23
    v_dot2c_f32_bf16 v18, v69, v23
    v_dot2c_f32_bf16 v18, v70, v23
    v_dot2c_f32_bf16 v18, v71, v23
    s_waitcnt lgkmcnt(10)
    v_mfma_f32_32x32x16_bf16 v[128:143], v[72:75], v[60:63], v[128:143]
    v_add_u32 v10, s63, v10
    v_add_u32 v7, s63, v7
    v_mfma_f32_32x32x16_bf16 v[144:159], v[72:75], v[64:67], v[144:159]
    v_add_u32 v14, s53, v14
    ds_read_b64_tr_b16 v[44:45], v14 offset:0
    ds_read_b64_tr_b16 v[46:47], v14 offset:1536
    v_dot2c_f32_bf16 v19, v72, v23
    v_dot2c_f32_bf16 v19, v73, v23
    v_dot2c_f32_bf16 v19, v74, v23
    v_dot2c_f32_bf16 v19, v75, v23
    s_waitcnt lgkmcnt(10)
    v_mfma_f32_32x32x16_bf16 v[160:175], v[76:79], v[60:63], v[160:175]
    v_add_u32 v11, s63, v11
    v_mfma_f32_32x32x16_bf16 v[176:191], v[76:79], v[64:67], v[176:191]
    v_add_u32 v15, s53, v15
    ds_read_b64_tr_b16 v[48:49], v15 offset:0
    ds_read_b64_tr_b16 v[50:51], v15 offset:1536
    v_dot2c_f32_bf16 v20, v76, v23
    v_dot2c_f32_bf16 v20, v77, v23
    v_dot2c_f32_bf16 v20, v78, v23
    v_dot2c_f32_bf16 v20, v79, v23
    s_waitcnt lgkmcnt(10)
    v_mfma_f32_32x32x16_bf16 v[192:207], v[80:83], v[60:63], v[192:207]
    v_add_u32 v8, s63, v8
    v_mfma_f32_32x32x16_bf16 v[208:223], v[80:83], v[64:67], v[208:223]
    v_add_u32 v16, s53, v16
    ds_read_b64_tr_b16 v[52:53], v16 offset:0
    ds_read_b64_tr_b16 v[54:55], v16 offset:512
    v_dot2c_f32_bf16 v21, v80, v23
    v_dot2c_f32_bf16 v21, v81, v23
    v_dot2c_f32_bf16 v21, v82, v23
    v_dot2c_f32_bf16 v21, v83, v23
    s_waitcnt lgkmcnt(10)
    v_mfma_f32_32x32x16_bf16 v[224:239], v[84:87], v[60:63], v[224:239]
    v_add_u32 v12, s63, v12
    v_mfma_f32_32x32x16_bf16 v[240:255], v[84:87], v[64:67], v[240:255]
    v_add_u32 v17, s53, v17
    ds_read_b64_tr_b16 v[56:57], v17 offset:0
    ds_read_b64_tr_b16 v[58:59], v17 offset:512
    v_dot2c_f32_bf16 v22, v84, v23
    v_dot2c_f32_bf16 v22, v85, v23
    v_dot2c_f32_bf16 v22, v86, v23
    v_dot2c_f32_bf16 v22, v87, v23
    s_nop 2
    v_mov_b32 v26, v18
    v_mov_b32 v27, v19
    v_mov_b32 v28, v20
    v_mov_b32 v29, v21
    v_mov_b32 v30, v22
    s_nop 1
    v_permlane32_swap_b32 v18, v26
    v_permlane32_swap_b32 v19, v27
    v_permlane32_swap_b32 v20, v28
    v_permlane32_swap_b32 v21, v29
    v_permlane32_swap_b32 v22, v30
    s_nop 0
    v_add_f32 v18, v18, v26
    v_add_f32 v19, v19, v27
    v_add_f32 v20, v20, v28
    v_add_f32 v21, v21, v29
    v_add_f32 v22, v22, v30
    s_lshl_b32 s31, s30, 4
    s_add_u32 s31, s31, s29
    s_mul_i32 s31, s31, 1280
    s_mul_i32 s32, s43, 640
    s_add_u32 s31, s31, s32
    s_add_u32 s31, s31, 10485760
    v_lshlrev_b32 v31, 2, v3
    s_mov_b32 exec_hi, 0
    buffer_store_dword v18, v31, s[24:27], s31 offen offset:0 sc1
    buffer_store_dword v19, v31, s[24:27], s31 offen offset:128 sc1
    buffer_store_dword v20, v31, s[24:27], s31 offen offset:256 sc1
    buffer_store_dword v21, v31, s[24:27], s31 offen offset:384 sc1
    buffer_store_dword v22, v31, s[24:27], s31 offen offset:512 sc1
    s_mov_b64 exec, -1
    s_mov_b32 s52, 9
.p2align 3
L_k1_loop1:
    s_cmp_eq_u32 s52, 8
    s_cbranch_scc1 L_k1_signal1
L_k1_signalled1:
    s_waitcnt lgkmcnt(8)
    v_mfma_f32_32x32x16_bf16 v[96:111], v[40:43], v[32:35], v[96:111]
    ds_read_b128 v[60:63], v6
    ds_read_b128 v[64:67], v10
    s_add_u32 s31, s51, 20480
    v_mfma_f32_32x32x16_bf16 v[112:127], v[40:43], v[36:39], v[112:127]
    ds_read_b64_tr_b16 v[68:69], v13 offset:6144
    ds_read_b64_tr_b16 v[70:71], v13 offset:7680
    s_cmp_eq_u32 s31, 102400
    s_waitcnt lgkmcnt(10)
    v_mfma_f32_32x32x16_bf16 v[128:143], v[44:47], v[32:35], v[128:143]
    s_cselect_b32 s31, 0, s31
    v_mfma_f32_32x32x16_bf16 v[144:159], v[44:47], v[36:39], v[144:159]
    ds_read_b64_tr_b16 v[72:73], v14 offset:6144
    ds_read_b64_tr_b16 v[74:75], v14 offset:7680
    s_sub_u32 s53, s31, s51
    s_waitcnt lgkmcnt(10)
    v_mfma_f32_32x32x16_bf16 v[160:175], v[48:51], v[32:35], v[160:175]
    s_mov_b32 s51, s31
    v_mfma_f32_32x32x16_bf16 v[176:191], v[48:51], v[36:39], v[176:191]
    ds_read_b64_tr_b16 v[76:77], v15 offset:6144
    ds_read_b64_tr_b16 v[78:79], v15 offset:7680
    s_waitcnt lgkmcnt(10)
    v_mfma_f32_32x32x16_bf16 v[192:207], v[52:55], v[32:35], v[192:207]
    v_mfma_f32_32x32x16_bf16 v[208:223], v[52:55], v[36:39], v[208:223]
    ds_read_b64_tr_b16 v[80:81], v16 offset:2048
    ds_read_b64_tr_b16 v[82:83], v16 offset:2560
    s_waitcnt lgkmcnt(10)
    v_mfma_f32_32x32x16_bf16 v[224:239], v[56:59], v[32:35], v[224:239]
    v_mfma_f32_32x32x16_bf16 v[240:255], v[56:59], v[36:39], v[240:255]
    ds_read_b64_tr_b16 v[84:85], v17 offset:2048
    ds_read_b64_tr_b16 v[86:87], v17 offset:2560
    s_barrier
    s_waitcnt lgkmcnt(8)
    v_mfma_f32_32x32x16_bf16 v[96:111], v[68:71], v[60:63], v[96:111]
    ds_read_b128 v[32:35], v7
    ds_read_b128 v[36:39], v11
    v_mfma_f32_32x32x16_bf16 v[112:127], v[68:71], v[64:67], v[112:127]
    v_add_u32 v13, s53, v13
    ds_read_b64_tr_b16 v[40:41], v13 offset:0
    ds_read_b64_tr_b16 v[42:43], v13 offset:1536
    s_waitcnt lgkmcnt(10)
    v_mfma_f32_32x32x16_bf16 v[128:143], v[72:75], v[60:63], v[128:143]
    v_mfma_f32_32x32x16_bf16 v[144:159], v[72:75], v[64:67], v[144:159]
    v_add_u32 v14, s53, v14
    ds_read_b64_tr_b16 v[44:45], v14 offset:0
    ds_read_b64_tr_b16 v[46:47], v14 offset:1536
    s_waitcnt lgkmcnt(10)
    v_mfma_f32_32x32x16_bf16 v[160:175], v[76:79], v[60:63], v[160:175]
    v_mfma_f32_32x32x16_bf16 v[176:191], v[76:79], v[64:67], v[176:191]
    v_add_u32 v15, s53, v15
    ds_read_b64_tr_b16 v[48:49], v15 offset:0
    ds_read_b64_tr_b16 v[50:51], v15 offset:1536
    s_waitcnt lgkmcnt(10)
    v_mfma_f32_32x32x16_bf16 v[192:207], v[80:83], v[60:63], v[192:207]
    v_mfma_f32_32x32x16_bf16 v[208:223], v[80:83], v[64:67], v[208:223]
    v_add_u32 v16, s53, v16
    ds_read_b64_tr_b16 v[52:53], v16 offset:0
    ds_read_b64_tr_b16 v[54:55], v16 offset:512
    s_waitcnt lgkmcnt(10)
    v_mfma_f32_32x32x16_bf16 v[224:239], v[84:87], v[60:63], v[224:239]
    v_mfma_f32_32x32x16_bf16 v[240:255], v[84:87], v[64:67], v[240:255]
    v_add_u32 v17, s53, v17
    ds_read_b64_tr_b16 v[56:57], v17 offset:0
    ds_read_b64_tr_b16 v[58:59], v17 offset:512
    s_waitcnt lgkmcnt(8)
    v_mfma_f32_32x32x16_bf16 v[96:111], v[40:43], v[32:35], v[96:111]
    ds_read_b128 v[60:63], v8
    ds_read_b128 v[64:67], v12
    s_add_u32 s31, s51, 20480
    v_mfma_f32_32x32x16_bf16 v[112:127], v[40:43], v[36:39], v[112:127]
    ds_read_b64_tr_b16 v[68:69], v13 offset:6144
    ds_read_b64_tr_b16 v[70:71], v13 offset:7680
    s_cmp_eq_u32 s31, 102400
    s_waitcnt lgkmcnt(10)
    v_mfma_f32_32x32x16_bf16 v[128:143], v[44:47], v[32:35], v[128:143]
    s_cselect_b32 s31, 0, s31
    v_mfma_f32_32x32x16_bf16 v[144:159], v[44:47], v[36:39], v[144:159]
    ds_read_b64_tr_b16 v[72:73], v14 offset:6144
    ds_read_b64_tr_b16 v[74:75], v14 offset:7680
    s_sub_u32 s53, s31, s51
    s_waitcnt lgkmcnt(10)
    v_mfma_f32_32x32x16_bf16 v[160:175], v[48:51], v[32:35], v[160:175]
    s_mov_b32 s51, s31
    v_mfma_f32_32x32x16_bf16 v[176:191], v[48:51], v[36:39], v[176:191]
    ds_read_b64_tr_b16 v[76:77], v15 offset:6144
    ds_read_b64_tr_b16 v[78:79], v15 offset:7680
    s_add_u32 s31, s50, 16384
    s_waitcnt lgkmcnt(10)
    v_mfma_f32_32x32x16_bf16 v[192:207], v[52:55], v[32:35], v[192:207]
    s_cmp_eq_u32 s31, 49152
    v_mfma_f32_32x32x16_bf16 v[208:223], v[52:55], v[36:39], v[208:223]
    ds_read_b64_tr_b16 v[80:81], v16 offset:2048
    ds_read_b64_tr_b16 v[82:83], v16 offset:2560
    s_cselect_b32 s31, 0, s31
    s_waitcnt lgkmcnt(10)
    v_mfma_f32_32x32x16_bf16 v[224:239], v[56:59], v[32:35], v[224:239]
    s_sub_u32 s63, s31, s50
    v_mfma_f32_32x32x16_bf16 v[240:255], v[56:59], v[36:39], v[240:255]
    ds_read_b64_tr_b16 v[84:85], v17 offset:2048
    ds_read_b64_tr_b16 v[86:87], v17 offset:2560
    s_mov_b32 s50, s31
    s_barrier
    s_waitcnt lgkmcnt(8)
    v_mfma_f32_32x32x16_bf16 v[96:111], v[68:71], v[60:63], v[96:111]
    v_add_u32 v5, s63, v5
    v_add_u32 v9, s63, v9
    ds_read_b128 v[32:35], v5
    ds_read_b128 v[36:39], v9
    v_add_u32 v6, s63, v6
    v_mfma_f32_32x32x16_bf16 v[112:127], v[68:71], v[64:67], v[112:127]
    v_add_u32 v13, s53, v13
    ds_read_b64_tr_b16 v[40:41], v13 offset:0
    ds_read_b64_tr_b16 v[42:43], v13 offset:1536
    v_add_u32 v10, s63, v10
    s_waitcnt lgkmcnt(10)
    v_mfma_f32_32x32x16_bf16 v[128:143], v[72:75], v[60:63], v[128:143]
    v_add_u32 v7, s63, v7
    v_mfma_f32_32x32x16_bf16 v[144:159], v[72:75], v[64:67], v[144:159]
    v_add_u32 v14, s53, v14
    ds_read_b64_tr_b16 v[44:45], v14 offset:0
    ds_read_b64_tr_b16 v[46:47], v14 offset:1536
    v_add_u32 v11, s63, v11
    s_waitcnt lgkmcnt(10)
    v_mfma_f32_32x32x16_bf16 v[160:175], v[76:79], v[60:63], v[160:175]
    v_add_u32 v8, s63, v8
    v_mfma_f32_32x32x16_bf16 v[176:191], v[76:79], v[64:67], v[176:191]
    v_add_u32 v15, s53, v15
    ds_read_b64_tr_b16 v[48:49], v15 offset:0
    ds_read_b64_tr_b16 v[50:51], v15 offset:1536
    v_add_u32 v12, s63, v12
    s_waitcnt lgkmcnt(10)
    v_mfma_f32_32x32x16_bf16 v[192:207], v[80:83], v[60:63], v[192:207]
    v_mfma_f32_32x32x16_bf16 v[208:223], v[80:83], v[64:67], v[208:223]
    v_add_u32 v16, s53, v16
    ds_read_b64_tr_b16 v[52:53], v16 offset:0
    ds_read_b64_tr_b16 v[54:55], v16 offset:512
    s_waitcnt lgkmcnt(10)
    v_mfma_f32_32x32x16_bf16 v[224:239], v[84:87], v[60:63], v[224:239]
    v_mfma_f32_32x32x16_bf16 v[240:255], v[84:87], v[64:67], v[240:255]
    v_add_u32 v17, s53, v17
    ds_read_b64_tr_b16 v[56:57], v17 offset:0
    ds_read_b64_tr_b16 v[58:59], v17 offset:512
    s_sub_u32 s52, s52, 1
    s_cmp_lg_u32 s52, 0
    s_cbranch_scc1 L_k1_loop1
    s_branch L_k1_post
L_k1_signal1:
    s_waitcnt vmcnt(0)
    v_mov_b32 v26, 153856
    v_mov_b32 v27, 1
    s_mov_b64 exec, 1
    ds_add_rtn_u32 v28, v26, v27
    s_waitcnt lgkmcnt(0)
    v_readfirstlane_b32 s31, v28
    v_mov_b32 v26, 0
    s_cmp_lg_u32 s31, 3
    s_cbranch_scc1 L_k1_nosig1
    global_atomic_add v26, v27, s[66:67]
L_k1_nosig1:
    s_mov_b64 exec, -1
    s_branch L_k1_signalled1
L_k1_post:
    s_waitcnt vmcnt(0) lgkmcnt(0)
    s_barrier
    s_lshl_b32 s31, s44, 8
    s_add_u32 s31, s31, 151552
    v_lshl_add_u32 v26, v3, 3, s31
    ds_read_b64 v[6:7], v26
    s_lshl_b32 s31, s45, 8
    s_add_u32 s31, s31, 151552
    v_lshl_add_u32 v26, v3, 3, s31
    ds_read_b64 v[8:9], v26
    s_mul_i32 s31, s43, 640
    s_add_u32 s31, s31, 152576
    v_lshl_add_u32 v5, v4, 4, s31
    v_lshlrev_b32 v30, 3, v3
    v_lshl_add_u32 v30, v4, 14, v30
    v_lshlrev_b32 v31, 4, v2
    s_lshl_b32 s31, s29, 2
    s_add_u32 s31, s31, s44
    s_lshl_b32 s54, s31, 8
    s_add_u32 s54, s54, 0
    s_mul_i32 s56, s31, 98304
    s_add_u32 s56, s56, 13631488
    s_lshl_b32 s31, s29, 2
    s_add_u32 s31, s31, s45
    s_lshl_b32 s55, s31, 8
    s_add_u32 s55, s55, 0
    s_mul_i32 s57, s31, 98304
    s_add_u32 s57, s57, 13631488
    s_waitcnt lgkmcnt(0)
    v_sub_f32 v10, 0, v6
    v_mov_b32 v14, v7
    v_mul_f32 v15, 0xbfb8aa3b, v7
    v_sub_f32 v12, 0, v8
    v_mov_b32 v16, v9
    v_mul_f32 v17, 0xbfb8aa3b, v9
    s_cmp_ge_u32 s30, 8
    s_cbranch_scc1 L_k1_epi1
    ds_read_b128 v[64:67], v5 offset:0
    ds_read_b128 v[68:71], v5 offset:32
    ds_read_b128 v[72:75], v5 offset:64
    ds_read_b128 v[76:79], v5 offset:96
    ds_read_b128 v[32:35], v5 offset:128
    ds_read_b128 v[36:39], v5 offset:160
    ds_read_b128 v[40:43], v5 offset:192
    ds_read_b128 v[44:47], v5 offset:224
    ds_read_b128 v[48:51], v5 offset:256
    ds_read_b128 v[52:55], v5 offset:288
    ds_read_b128 v[56:59], v5 offset:320
    ds_read_b128 v[60:63], v5 offset:352
    s_lshl_b32 s58, s35, 4
    s_lshl_b32 s31, s43, 3
    s_add_u32 s58, s58, s31
    s_lshr_b32 s60, s58, 1
    s_waitcnt lgkmcnt(8)
    s_cmp_lt_u32 s58, 160
    s_cselect_b32 s59, 0x3ea52b5c, 1.0
    s_lshl_b32 s32, s58, 14
    v_mul_f32 v20, s59, v7
    v_mul_f32 v22, s59, v9
    v_pk_fma_f32 v[96:97], v[64:65], v[10:11], v[96:97] op_sel_hi:[1,0,1]
    v_pk_fma_f32 v[98:99], v[66:67], v[10:11], v[98:99] op_sel_hi:[1,0,1]
    v_pk_fma_f32 v[112:113], v[64:65], v[12:13], v[112:113] op_sel_hi:[1,0,1]
    v_pk_fma_f32 v[114:115], v[66:67], v[12:13], v[114:115] op_sel_hi:[1,0,1]
    v_pk_mul_f32 v[96:97], v[96:97], v[20:21] op_sel_hi:[1,0]
    v_pk_mul_f32 v[98:99], v[98:99], v[20:21] op_sel_hi:[1,0]
    v_pk_mul_f32 v[112:113], v[112:113], v[22:23] op_sel_hi:[1,0]
    v_pk_mul_f32 v[114:115], v[114:115], v[22:23] op_sel_hi:[1,0]
    v_cvt_pk_bf16_f32 v96, v96, v97
    v_cvt_pk_bf16_f32 v97, v98, v99
    v_cvt_pk_bf16_f32 v112, v112, v113
    v_cvt_pk_bf16_f32 v113, v114, v115
    s_add_u32 s31, s32, s54
    s_add_u32 s31, s31, 0
    buffer_store_dwordx2 v[96:97], v30, s[24:27], s31 offen sc1
    s_add_u32 s31, s32, s55
    s_add_u32 s31, s31, 0
    buffer_store_dwordx2 v[112:113], v30, s[24:27], s31 offen sc1
    v_pk_fma_f32 v[100:101], v[68:69], v[10:11], v[100:101] op_sel_hi:[1,0,1]
    v_pk_fma_f32 v[102:103], v[70:71], v[10:11], v[102:103] op_sel_hi:[1,0,1]
    v_pk_fma_f32 v[116:117], v[68:69], v[12:13], v[116:117] op_sel_hi:[1,0,1]
    v_pk_fma_f32 v[118:119], v[70:71], v[12:13], v[118:119] op_sel_hi:[1,0,1]
    v_pk_mul_f32 v[100:101], v[100:101], v[20:21] op_sel_hi:[1,0]
    v_pk_mul_f32 v[102:103], v[102:103], v[20:21] op_sel_hi:[1,0]
    v_pk_mul_f32 v[116:117], v[116:117], v[22:23] op_sel_hi:[1,0]
    v_pk_mul_f32 v[118:119], v[118:119], v[22:23] op_sel_hi:[1,0]
    v_cvt_pk_bf16_f32 v100, v100, v101
    v_cvt_pk_bf16_f32 v101, v102, v103
    v_cvt_pk_bf16_f32 v116, v116, v117
    v_cvt_pk_bf16_f32 v117, v118, v119
    s_add_u32 s31, s32, s54
    s_add_u32 s31, s31, 32768
    buffer_store_dwordx2 v[100:101], v30, s[24:27], s31 offen sc1
    s_add_u32 s31, s32, s55
    s_add_u32 s31, s31, 32768
    buffer_store_dwordx2 v[116:117], v30, s[24:27], s31 offen sc1
    v_pk_fma_f32 v[104:105], v[72:73], v[10:11], v[104:105] op_sel_hi:[1,0,1]
    v_pk_fma_f32 v[106:107], v[74:75], v[10:11], v[106:107] op_sel_hi:[1,0,1]
    v_pk_fma_f32 v[120:121], v[72:73], v[12:13], v[120:121] op_sel_hi:[1,0,1]
    v_pk_fma_f32 v[122:123], v[74:75], v[12:13], v[122:123] op_sel_hi:[1,0,1]
    v_pk_mul_f32 v[104:105], v[104:105], v[20:21] op_sel_hi:[1,0]
    v_pk_mul_f32 v[106:107], v[106:107], v[20:21] op_sel_hi:[1,0]
    v_pk_mul_f32 v[120:121], v[120:121], v[22:23] op_sel_hi:[1,0]
    v_pk_mul_f32 v[122:123], v[122:123], v[22:23] op_sel_hi:[1,0]
    v_cvt_pk_bf16_f32 v104, v104, v105
    v_cvt_pk_bf16_f32 v105, v106, v107
    v_cvt_pk_bf16_f32 v120, v120, v121
    v_cvt_pk_bf16_f32 v121, v122, v123
    s_add_u32 s31, s32, s54
    s_add_u32 s31, s31, 65536
    buffer_store_dwordx2 v[104:105], v30, s[24:27], s31 offen sc1
    s_add_u32 s31, s32, s55
    s_add_u32 s31, s31, 65536
    buffer_store_dwordx2 v[120:121], v30, s[24:27], s31 offen sc1
    v_pk_fma_f32 v[108:109], v[76:77], v[10:11], v[108:109] op_sel_hi:[1,0,1]
    v_pk_fma_f32 v[110:111], v[78:79], v[10:11], v[110:111] op_sel_hi:[1,0,1]
    v_pk_fma_f32 v[124:125], v[76:77], v[12:13], v[124:125] op_sel_hi:[1,0,1]
    v_pk_fma_f32 v[126:127], v[78:79], v[12:13], v[126:127] op_sel_hi:[1,0,1]
    v_pk_mul_f32 v[108:109], v[108:109], v[20:21] op_sel_hi:[1,0]
    v_pk_mul_f32 v[110:111], v[110:111], v[20:21] op_sel_hi:[1,0]
    v_pk_mul_f32 v[124:125], v[124:125], v[22:23] op_sel_hi:[1,0]
    v_pk_mul_f32 v[126:127], v[126:127], v[22:23] op_sel_hi:[1,0]
    v_cvt_pk_bf16_f32 v108, v108, v109
    v_cvt_pk_bf16_f32 v109, v110, v111
    v_cvt_pk_bf16_f32 v124, v124, v125
    v_cvt_pk_bf16_f32 v125, v126, v127
    s_add_u32 s31, s32, s54
    s_add_u32 s31, s31, 98304
    buffer_store_dwordx2 v[108:109], v30, s[24:27], s31 offen sc1
    s_add_u32 s31, s32, s55
    s_add_u32 s31, s31, 98304
    buffer_store_dwordx2 v[124:125], v30, s[24:27], s31 offen sc1
    s_waitcnt lgkmcnt(0)
    v_pk_fma_f32 v[128:129], v[32:33], v[10:11], v[128:129] op_sel_hi:[1,0,1]
    v_pk_fma_f32 v[160:161], v[48:49], v[10:11], v[160:161] op_sel_hi:[1,0,1]
    v_pk_fma_f32 v[130:131], v[34:35], v[10:11], v[130:131] op_sel_hi:[1,0,1]
    v_pk_fma_f32 v[162:163], v[50:51], v[10:11], v[162:163] op_sel_hi:[1,0,1]
    v_pk_fma_f32 v[132:133], v[36:37], v[10:11], v[132:133] op_sel_hi:[1,0,1]
    v_pk_fma_f32 v[164:165], v[52:53], v[10:11], v[164:165] op_sel_hi:[1,0,1]
    v_pk_fma_f32 v[134:135], v[38:39], v[10:11], v[134:135] op_sel_hi:[1,0,1]
    v_pk_fma_f32 v[166:167], v[54:55], v[10:11], v[166:167] op_sel_hi:[1,0,1]
    v_pk_fma_f32 v[136:137], v[40:41], v[10:11], v[136:137] op_sel_hi:[1,0,1]
    v_pk_fma_f32 v[168:169], v[56:57], v[10:11], v[168:169] op_sel_hi:[1,0,1]
    v_pk_fma_f32 v[138:139], v[42:43], v[10:11], v[138:139] op_sel_hi:[1,0,1]
    v_pk_fma_f32 v[170:171], v[58:59], v[10:11], v[170:171] op_sel_hi:[1,0,1]
    v_pk_fma_f32 v[140:141], v[44:45], v[10:11], v[140:141] op_sel_hi:[1,0,1]
    v_pk_fma_f32 v[172:173], v[60:61], v[10:11], v[172:173] op_sel_hi:[1,0,1]
    v_pk_fma_f32 v[142:143], v[46:47], v[10:11], v[142:143] op_sel_hi:[1,0,1]
    v_pk_fma_f32 v[174:175], v[62:63], v[10:11], v[174:175] op_sel_hi:[1,0,1]
    v_pk_mul_f32 v[18:19], v[128:129], v[14:15] op_sel:[0,1] op_sel_hi:[1,1]
    v_pk_mul_f32 v[20:21], v[130:131], v[14:15] op_sel:[0,1] op_sel_hi:[1,1]
    v_pk_mul_f32 v[22:23], v[132:133], v[14:15] op_sel:[0,1] op_sel_hi:[1,1]
    v_pk_mul_f32 v[24:25], v[134:135], v[14:15] op_sel:[0,1] op_sel_hi:[1,1]
    v_pk_mul_f32 v[128:129], v[128:129], v[14:15] op_sel_hi:[1,0]
    v_pk_mul_f32 v[130:131], v[130:131], v[14:15] op_sel_hi:[1,0]
    v_pk_mul_f32 v[132:133], v[132:133], v[14:15] op_sel_hi:[1,0]
    v_pk_mul_f32 v[134:135], v[134:135], v[14:15] op_sel_hi:[1,0]
    v_exp_f32 v18, v18
    v_exp_f32 v19, v19
    v_exp_f32 v20, v20
    v_exp_f32 v21, v21
    v_exp_f32 v22, v22
    v_exp_f32 v23, v23
    v_exp_f32 v24, v24
    v_exp_f32 v25, v25
    v_pk_mul_f32 v[160:161], v[160:161], v[14:15] op_sel_hi:[1,0]
    v_pk_mul_f32 v[162:163], v[162:163], v[14:15] op_sel_hi:[1,0]
    v_pk_mul_f32 v[164:165], v[164:165], v[14:15] op_sel_hi:[1,0]
    v_pk_mul_f32 v[166:167], v[166:167], v[14:15] op_sel_hi:[1,0]
    v_pk_add_f32 v[18:19], v[18:19], 1.0 op_sel_hi:[1,0]
    v_pk_add_f32 v[20:21], v[20:21], 1.0 op_sel_hi:[1,0]
    v_pk_add_f32 v[22:23], v[22:23], 1.0 op_sel_hi:[1,0]
    v_pk_add_f32 v[24:25], v[24:25], 1.0 op_sel_hi:[1,0]
    v_pk_mul_f32 v[160:161], v[160:161], v[128:129]
    v_pk_mul_f32 v[162:163], v[162:163], v[130:131]
    v_pk_mul_f32 v[164:165], v[164:165], v[132:133]
    v_pk_mul_f32 v[166:167], v[166:167], v[134:135]
    v_rcp_f32 v18, v18
    v_rcp_f32 v19, v19
    v_rcp_f32 v20, v20
    v_rcp_f32 v21, v21
    v_rcp_f32 v22, v22
    v_rcp_f32 v23, v23
    v_rcp_f32 v24, v24
    v_rcp_f32 v25, v25
    s_add_u32 s31, s60, 0
    s_lshl_b32 s31, s31, 10
    s_add_u32 s31, s31, s56
    v_pk_mul_f32 v[160:161], v[160:161], v[18:19]
    v_pk_mul_f32 v[162:163], v[162:163], v[20:21]
    v_pk_mul_f32 v[164:165], v[164:165], v[22:23]
    v_pk_mul_f32 v[166:167], v[166:167], v[24:25]
    v_cvt_pk_bf16_f32 v128, v160, v161
    v_cvt_pk_bf16_f32 v129, v162, v163
    v_cvt_pk_bf16_f32 v130, v164, v165
    v_cvt_pk_bf16_f32 v131, v166, v167
    buffer_store_dwordx4 v[128:131], v31, s[24:27], s31 offen sc1
    v_pk_mul_f32 v[18:19], v[136:137], v[14:15] op_sel:[0,1] op_sel_hi:[1,1]
    v_pk_mul_f32 v[20:21], v[138:139], v[14:15] op_sel:[0,1] op_sel_hi:[1,1]
    v_pk_mul_f32 v[22:23], v[140:141], v[14:15] op_sel:[0,1] op_sel_hi:[1,1]
    v_pk_mul_f32 v[24:25], v[142:143], v[14:15] op_sel:[0,1] op_sel_hi:[1,1]
    v_pk_mul_f32 v[136:137], v[136:137], v[14:15] op_sel_hi:[1,0]
    v_pk_mul_f32 v[138:139], v[138:139], v[14:15] op_sel_hi:[1,0]
    v_pk_mul_f32 v[140:141], v[140:141], v[14:15] op_sel_hi:[1,0]
    v_pk_mul_f32 v[142:143], v[142:143], v[14:15] op_sel_hi:[1,0]
    v_exp_f32 v18, v18
    v_exp_f32 v19, v19
    v_exp_f32 v20, v20
    v_exp_f32 v21, v21
    v_exp_f32 v22, v22
    v_exp_f32 v23, v23
    v_exp_f32 v24, v24
    v_exp_f32 v25, v25
    v_pk_mul_f32 v[168:169], v[168:169], v[14:15] op_sel_hi:[1,0]
    v_pk_mul_f32 v[170:171], v[170:171], v[14:15] op_sel_hi:[1,0]
    v_pk_mul_f32 v[172:173], v[172:173], v[14:15] op_sel_hi:[1,0]
    v_pk_mul_f32 v[174:175], v[174:175], v[14:15] op_sel_hi:[1,0]
    v_pk_add_f32 v[18:19], v[18:19], 1.0 op_sel_hi:[1,0]
    v_pk_add_f32 v[20:21], v[20:21], 1.0 op_sel_hi:[1,0]
    v_pk_add_f32 v[22:23], v[22:23], 1.0 op_sel_hi:[1,0]
    v_pk_add_f32 v[24:25], v[24:25], 1.0 op_sel_hi:[1,0]
    v_pk_mul_f32 v[168:169], v[168:169], v[136:137]
    v_pk_mul_f32 v[170:171], v[170:171], v[138:139]
    v_pk_mul_f32 v[172:173], v[172:173], v[140:141]
    v_pk_mul_f32 v[174:175], v[174:175], v[142:143]
    v_rcp_f32 v18, v18
    v_rcp_f32 v19, v19
    v_rcp_f32 v20, v20
    v_rcp_f32 v21, v21
    v_rcp_f32 v22, v22
    v_rcp_f32 v23, v23
    v_rcp_f32 v24, v24
    v_rcp_f32 v25, v25
    s_add_u32 s31, s60, 1
    s_lshl_b32 s31, s31, 10
    s_add_u32 s31, s31, s56
    v_pk_mul_f32 v[168:169], v[168:169], v[18:19]
    v_pk_mul_f32 v[170:171], v[170:171], v[20:21]
    v_pk_mul_f32 v[172:173], v[172:173], v[22:23]
    v_pk_mul_f32 v[174:175], v[174:175], v[24:25]
    v_cvt_pk_bf16_f32 v136, v168, v169
    v_cvt_pk_bf16_f32 v137, v170, v171
    v_cvt_pk_bf16_f32 v138, v172, v173
    v_cvt_pk_bf16_f32 v139, v174, v175
    buffer_store_dwordx4 v[136:139], v31, s[24:27], s31 offen sc1
    v_pk_fma_f32 v[144:145], v[32:33], v[12:13], v[144:145] op_sel_hi:[1,0,1]
    v_pk_fma_f32 v[176:177], v[48:49], v[12:13], v[176:177] op_sel_hi:[1,0,1]
    v_pk_fma_f32 v[146:147], v[34:35], v[12:13], v[146:147] op_sel_hi:[1,0,1]
    v_pk_fma_f32 v[178:179], v[50:51], v[12:13], v[178:179] op_sel_hi:[1,0,1]
    v_pk_fma_f32 v[148:149], v[36:37], v[12:13], v[148:149] op_sel_hi:[1,0,1]
    v_pk_fma_f32 v[180:181], v[52:53], v[12:13], v[180:181] op_sel_hi:[1,0,1]
    v_pk_fma_f32 v[150:151], v[38:39], v[12:13], v[150:151] op_sel_hi:[1,0,1]
    v_pk_fma_f32 v[182:183], v[54:55], v[12:13], v[182:183] op_sel_hi:[1,0,1]
    v_pk_fma_f32 v[152:153], v[40:41], v[12:13], v[152:153] op_sel_hi:[1,0,1]
    v_pk_fma_f32 v[184:185], v[56:57], v[12:13], v[184:185] op_sel_hi:[1,0,1]
    v_pk_fma_f32 v[154:155], v[42:43], v[12:13], v[154:155] op_sel_hi:[1,0,1]
    v_pk_fma_f32 v[186:187], v[58:59], v[12:13], v[186:187] op_sel_hi:[1,0,1]
    v_pk_fma_f32 v[156:157], v[44:45], v[12:13], v[156:157] op_sel_hi:[1,0,1]
    v_pk_fma_f32 v[188:189], v[60:61], v[12:13], v[188:189] op_sel_hi:[1,0,1]
    v_pk_fma_f32 v[158:159], v[46:47], v[12:13], v[158:159] op_sel_hi:[1,0,1]
    v_pk_fma_f32 v[190:191], v[62:63], v[12:13], v[190:191] op_sel_hi:[1,0,1]
    v_pk_mul_f32 v[18:19], v[144:145], v[16:17] op_sel:[0,1] op_sel_hi:[1,1]
    v_pk_mul_f32 v[20:21], v[146:147], v[16:17] op_sel:[0,1] op_sel_hi:[1,1]
    v_pk_mul_f32 v[22:23], v[148:149], v[16:17] op_sel:[0,1] op_sel_hi:[1,1]
    v_pk_mul_f32 v[24:25], v[150:151], v[16:17] op_sel:[0,1] op_sel_hi:[1,1]
    v_pk_mul_f32 v[144:145], v[144:145], v[16:17] op_sel_hi:[1,0]
    v_pk_mul_f32 v[146:147], v[146:147], v[16:17] op_sel_hi:[1,0]
    v_pk_mul_f32 v[148:149], v[148:149], v[16:17] op_sel_hi:[1,0]
    v_pk_mul_f32 v[150:151], v[150:151], v[16:17] op_sel_hi:[1,0]
    v_exp_f32 v18, v18
    v_exp_f32 v19, v19
    v_exp_f32 v20, v20
    v_exp_f32 v21, v21
    v_exp_f32 v22, v22
    v_exp_f32 v23, v23
    v_exp_f32 v24, v24
    v_exp_f32 v25, v25
    v_pk_mul_f32 v[176:177], v[176:177], v[16:17] op_sel_hi:[1,0]
    v_pk_mul_f32 v[178:179], v[178:179], v[16:17] op_sel_hi:[1,0]
    v_pk_mul_f32 v[180:181], v[180:181], v[16:17] op_sel_hi:[1,0]
    v_pk_mul_f32 v[182:183], v[182:183], v[16:17] op_sel_hi:[1,0]
    v_pk_add_f32 v[18:19], v[18:19], 1.0 op_sel_hi:[1,0]
    v_pk_add_f32 v[20:21], v[20:21], 1.0 op_sel_hi:[1,0]
    v_pk_add_f32 v[22:23], v[22:23], 1.0 op_sel_hi:[1,0]
    v_pk_add_f32 v[24:25], v[24:25], 1.0 op_sel_hi:[1,0]
    v_pk_mul_f32 v[176:177], v[176:177], v[144:145]
    v_pk_mul_f32 v[178:179], v[178:179], v[146:147]
    v_pk_mul_f32 v[180:181], v[180:181], v[148:149]
    v_pk_mul_f32 v[182:183], v[182:183], v[150:151]
    v_rcp_f32 v18, v18
    v_rcp_f32 v19, v19
    v_rcp_f32 v20, v20
    v_rcp_f32 v21, v21
    v_rcp_f32 v22, v22
    v_rcp_f32 v23, v23
    v_rcp_f32 v24, v24
    v_rcp_f32 v25, v25
    s_add_u32 s31, s60, 0
    s_lshl_b32 s31, s31, 10
    s_add_u32 s31, s31, s57
    v_pk_mul_f32 v[176:177], v[176:177], v[18:19]
    v_pk_mul_f32 v[178:179], v[178:179], v[20:21]
    v_pk_mul_f32 v[180:181], v[180:181], v[22:23]
    v_pk_mul_f32 v[182:183], v[182:183], v[24:25]
    v_cvt_pk_bf16_f32 v144, v176, v177
    v_cvt_pk_bf16_f32 v145, v178, v179
    v_cvt_pk_bf16_f32 v146, v180, v181
    v_cvt_pk_bf16_f32 v147, v182, v183
    buffer_store_dwordx4 v[144:147], v31, s[24:27], s31 offen sc1
    v_pk_mul_f32 v[18:19], v[152:153], v[16:17] op_sel:[0,1] op_sel_hi:[1,1]
    v_pk_mul_f32 v[20:21], v[154:155], v[16:17] op_sel:[0,1] op_sel_hi:[1,1]
    v_pk_mul_f32 v[22:23], v[156:157], v[16:17] op_sel:[0,1] op_sel_hi:[1,1]
    v_pk_mul_f32 v[24:25], v[158:159], v[16:17] op_sel:[0,1] op_sel_hi:[1,1]
    v_pk_mul_f32 v[152:153], v[152:153], v[16:17] op_sel_hi:[1,0]
    v_pk_mul_f32 v[154:155], v[154:155], v[16:17] op_sel_hi:[1,0]
    v_pk_mul_f32 v[156:157], v[156:157], v[16:17] op_sel_hi:[1,0]
    v_pk_mul_f32 v[158:159], v[158:159], v[16:17] op_sel_hi:[1,0]
    v_exp_f32 v18, v18
    v_exp_f32 v19, v19
    v_exp_f32 v20, v20
    v_exp_f32 v21, v21
    v_exp_f32 v22, v22
    v_exp_f32 v23, v23
    v_exp_f32 v24, v24
    v_exp_f32 v25, v25
    v_pk_mul_f32 v[184:185], v[184:185], v[16:17] op_sel_hi:[1,0]
    v_pk_mul_f32 v[186:187], v[186:187], v[16:17] op_sel_hi:[1,0]
    v_pk_mul_f32 v[188:189], v[188:189], v[16:17] op_sel_hi:[1,0]
    v_pk_mul_f32 v[190:191], v[190:191], v[16:17] op_sel_hi:[1,0]
    v_pk_add_f32 v[18:19], v[18:19], 1.0 op_sel_hi:[1,0]
    v_pk_add_f32 v[20:21], v[20:21], 1.0 op_sel_hi:[1,0]
    v_pk_add_f32 v[22:23], v[22:23], 1.0 op_sel_hi:[1,0]
    v_pk_add_f32 v[24:25], v[24:25], 1.0 op_sel_hi:[1,0]
    v_pk_mul_f32 v[184:185], v[184:185], v[152:153]
    v_pk_mul_f32 v[186:187], v[186:187], v[154:155]
    v_pk_mul_f32 v[188:189], v[188:189], v[156:157]
    v_pk_mul_f32 v[190:191], v[190:191], v[158:159]
    v_rcp_f32 v18, v18
    v_rcp_f32 v19, v19
    v_rcp_f32 v20, v20
    v_rcp_f32 v21, v21
    v_rcp_f32 v22, v22
    v_rcp_f32 v23, v23
    v_rcp_f32 v24, v24
    v_rcp_f32 v25, v25
    s_add_u32 s31, s60, 1
    s_lshl_b32 s31, s31, 10
    s_add_u32 s31, s31, s57
    v_pk_mul_f32 v[184:185], v[184:185], v[18:19]
    v_pk_mul_f32 v[186:187], v[186:187], v[20:21]
    v_pk_mul_f32 v[188:189], v[188:189], v[22:23]
    v_pk_mul_f32 v[190:191], v[190:191], v[24:25]
    v_cvt_pk_bf16_f32 v152, v184, v185
    v_cvt_pk_bf16_f32 v153, v186, v187
    v_cvt_pk_bf16_f32 v154, v188, v189
    v_cvt_pk_bf16_f32 v155, v190, v191
    buffer_store_dwordx4 v[152:155], v31, s[24:27], s31 offen sc1
    ds_read_b128 v[32:35], v5 offset:384
    ds_read_b128 v[36:39], v5 offset:416
    ds_read_b128 v[40:43], v5 offset:448
    ds_read_b128 v[44:47], v5 offset:480
    ds_read_b128 v[48:51], v5 offset:512
    ds_read_b128 v[52:55], v5 offset:544
    ds_read_b128 v[56:59], v5 offset:576
    ds_read_b128 v[60:63], v5 offset:608
    s_add_u32 s60, s60, 2
    s_waitcnt lgkmcnt(0)
    v_pk_fma_f32 v[192:193], v[32:33], v[10:11], v[192:193] op_sel_hi:[1,0,1]
    v_pk_fma_f32 v[224:225], v[48:49], v[10:11], v[224:225] op_sel_hi:[1,0,1]
    v_pk_fma_f32 v[194:195], v[34:35], v[10:11], v[194:195] op_sel_hi:[1,0,1]
    v_pk_fma_f32 v[226:227], v[50:51], v[10:11], v[226:227] op_sel_hi:[1,0,1]
    v_pk_fma_f32 v[196:197], v[36:37], v[10:11], v[196:197] op_sel_hi:[1,0,1]
    v_pk_fma_f32 v[228:229], v[52:53], v[10:11], v[228:229] op_sel_hi:[1,0,1]
    v_pk_fma_f32 v[198:199], v[38:39], v[10:11], v[198:199] op_sel_hi:[1,0,1]
    v_pk_fma_f32 v[230:231], v[54:55], v[10:11], v[230:231] op_sel_hi:[1,0,1]
    v_pk_fma_f32 v[200:201], v[40:41], v[10:11], v[200:201] op_sel_hi:[1,0,1]
    v_pk_fma_f32 v[232:233], v[56:57], v[10:11], v[232:233] op_sel_hi:[1,0,1]
    v_pk_fma_f32 v[202:203], v[42:43], v[10:11], v[202:203] op_sel_hi:[1,0,1]
    v_pk_fma_f32 v[234:235], v[58:59], v[10:11], v[234:235] op_sel_hi:[1,0,1]
    v_pk_fma_f32 v[204:205], v[44:45], v[10:11], v[204:205] op_sel_hi:[1,0,1]
    v_pk_fma_f32 v[236:237], v[60:61], v[10:11], v[236:237] op_sel_hi:[1,0,1]
    v_pk_fma_f32 v[206:207], v[46:47], v[10:11], v[206:207] op_sel_hi:[1,0,1]
    v_pk_fma_f32 v[238:239], v[62:63], v[10:11], v[238:239] op_sel_hi:[1,0,1]
    v_pk_mul_f32 v[18:19], v[192:193], v[14:15] op_sel:[0,1] op_sel_hi:[1,1]
    v_pk_mul_f32 v[20:21], v[194:195], v[14:15] op_sel:[0,1] op_sel_hi:[1,1]
    v_pk_mul_f32 v[22:23], v[196:197], v[14:15] op_sel:[0,1] op_sel_hi:[1,1]
    v_pk_mul_f32 v[24:25], v[198:199], v[14:15] op_sel:[0,1] op_sel_hi:[1,1]
    v_pk_mul_f32 v[192:193], v[192:193], v[14:15] op_sel_hi:[1,0]
    v_pk_mul_f32 v[194:195], v[194:195], v[14:15] op_sel_hi:[1,0]
    v_pk_mul_f32 v[196:197], v[196:197], v[14:15] op_sel_hi:[1,0]
    v_pk_mul_f32 v[198:199], v[198:199], v[14:15] op_sel_hi:[1,0]
    v_exp_f32 v18, v18
    v_exp_f32 v19, v19
    v_exp_f32 v20, v20
    v_exp_f32 v21, v21
    v_exp_f32 v22, v22
    v_exp_f32 v23, v23
    v_exp_f32 v24, v24
    v_exp_f32 v25, v25
    v_pk_mul_f32 v[224:225], v[224:225], v[14:15] op_sel_hi:[1,0]
    v_pk_mul_f32 v[226:227], v[226:227], v[14:15] op_sel_hi:[1,0]
    v_pk_mul_f32 v[228:229], v[228:229], v[14:15] op_sel_hi:[1,0]
    v_pk_mul_f32 v[230:231], v[230:231], v[14:15] op_sel_hi:[1,0]
    v_pk_add_f32 v[18:19], v[18:19], 1.0 op_sel_hi:[1,0]
    v_pk_add_f32 v[20:21], v[20:21], 1.0 op_sel_hi:[1,0]
    v_pk_add_f32 v[22:23], v[22:23], 1.0 op_sel_hi:[1,0]
    v_pk_add_f32 v[24:25], v[24:25], 1.0 op_sel_hi:[1,0]
    v_pk_mul_f32 v[224:225], v[224:225], v[192:193]
    v_pk_mul_f32 v[226:227], v[226:227], v[194:195]
    v_pk_mul_f32 v[228:229], v[228:229], v[196:197]
    v_pk_mul_f32 v[230:231], v[230:231], v[198:199]
    v_rcp_f32 v18, v18
    v_rcp_f32 v19, v19
    v_rcp_f32 v20, v20
    v_rcp_f32 v21, v21
    v_rcp_f32 v22, v22
    v_rcp_f32 v23, v23
    v_rcp_f32 v24, v24
    v_rcp_f32 v25, v25
    s_add_u32 s31, s60, 0
    s_lshl_b32 s31, s31, 10
    s_add_u32 s31, s31, s56
    v_pk_mul_f32 v[224:225], v[224:225], v[18:19]
    v_pk_mul_f32 v[226:227], v[226:227], v[20:21]
    v_pk_mul_f32 v[228:229], v[228:229], v[22:23]
    v_pk_mul_f32 v[230:231], v[230:231], v[24:25]
    v_cvt_pk_bf16_f32 v192, v224, v225
    v_cvt_pk_bf16_f32 v193, v226, v227
    v_cvt_pk_bf16_f32 v194, v228, v229
    v_cvt_pk_bf16_f32 v195, v230, v231
    buffer_store_dwordx4 v[192:195], v31, s[24:27], s31 offen sc1
    v_pk_mul_f32 v[18:19], v[200:201], v[14:15] op_sel:[0,1] op_sel_hi:[1,1]
    v_pk_mul_f32 v[20:21], v[202:203], v[14:15] op_sel:[0,1] op_sel_hi:[1,1]
    v_pk_mul_f32 v[22:23], v[204:205], v[14:15] op_sel:[0,1] op_sel_hi:[1,1]
    v_pk_mul_f32 v[24:25], v[206:207], v[14:15] op_sel:[0,1] op_sel_hi:[1,1]
    v_pk_mul_f32 v[200:201], v[200:201], v[14:15] op_sel_hi:[1,0]
    v_pk_mul_f32 v[202:203], v[202:203], v[14:15] op_sel_hi:[1,0]
    v_pk_mul_f32 v[204:205], v[204:205], v[14:15] op_sel_hi:[1,0]
    v_pk_mul_f32 v[206:207], v[206:207], v[14:15] op_sel_hi:[1,0]
    v_exp_f32 v18, v18
    v_exp_f32 v19, v19
    v_exp_f32 v20, v20
    v_exp_f32 v21, v21
    v_exp_f32 v22, v22
    v_exp_f32 v23, v23
    v_exp_f32 v24, v24
    v_exp_f32 v25, v25
    v_pk_mul_f32 v[232:233], v[232:233], v[14:15] op_sel_hi:[1,0]
    v_pk_mul_f32 v[234:235], v[234:235], v[14:15] op_sel_hi:[1,0]
    v_pk_mul_f32 v[236:237], v[236:237], v[14:15] op_sel_hi:[1,0]
    v_pk_mul_f32 v[238:239], v[238:239], v[14:15] op_sel_hi:[1,0]
    v_pk_add_f32 v[18:19], v[18:19], 1.0 op_sel_hi:[1,0]
    v_pk_add_f32 v[20:21], v[20:21], 1.0 op_sel_hi:[1,0]
    v_pk_add_f32 v[22:23], v[22:23], 1.0 op_sel_hi:[1,0]
    v_pk_add_f32 v[24:25], v[24:25], 1.0 op_sel_hi:[1,0]
    v_pk_mul_f32 v[232:233], v[232:233], v[200:201]
    v_pk_mul_f32 v[234:235], v[234:235], v[202:203]
    v_pk_mul_f32 v[236:237], v[236:237], v[204:205]
    v_pk_mul_f32 v[238:239], v[238:239], v[206:207]
    v_rcp_f32 v18, v18
    v_rcp_f32 v19, v19
    v_rcp_f32 v20, v20
    v_rcp_f32 v21, v21
    v_rcp_f32 v22, v22
    v_rcp_f32 v23, v23
    v_rcp_f32 v24, v24
    v_rcp_f32 v25, v25
    s_add_u32 s31, s60, 1
    s_lshl_b32 s31, s31, 10
    s_add_u32 s31, s31, s56
    v_pk_mul_f32 v[232:233], v[232:233], v[18:19]
    v_pk_mul_f32 v[234:235], v[234:235], v[20:21]
    v_pk_mul_f32 v[236:237], v[236:237], v[22:23]
    v_pk_mul_f32 v[238:239], v[238:239], v[24:25]
    v_cvt_pk_bf16_f32 v200, v232, v233
    v_cvt_pk_bf16_f32 v201, v234, v235
    v_cvt_pk_bf16_f32 v202, v236, v237
    v_cvt_pk_bf16_f32 v203, v238, v239
    buffer_store_dwordx4 v[200:203], v31, s[24:27], s31 offen sc1
    v_pk_fma_f32 v[208:209], v[32:33], v[12:13], v[208:209] op_sel_hi:[1,0,1]
    v_pk_fma_f32 v[240:241], v[48:49], v[12:13], v[240:241] op_sel_hi:[1,0,1]
    v_pk_fma_f32 v[210:211], v[34:35], v[12:13], v[210:211] op_sel_hi:[1,0,1]
    v_pk_fma_f32 v[242:243], v[50:51], v[12:13], v[242:243] op_sel_hi:[1,0,1]
    v_pk_fma_f32 v[212:213], v[36:37], v[12:13], v[212:213] op_sel_hi:[1,0,1]
    v_pk_fma_f32 v[244:245], v[52:53], v[12:13], v[244:245] op_sel_hi:[1,0,1]
    v_pk_fma_f32 v[214:215], v[38:39], v[12:13], v[214:215] op_sel_hi:[1,0,1]
    v_pk_fma_f32 v[246:247], v[54:55], v[12:13], v[246:247] op_sel_hi:[1,0,1]
    v_pk_fma_f32 v[216:217], v[40:41], v[12:13], v[216:217] op_sel_hi:[1,0,1]
    v_pk_fma_f32 v[248:249], v[56:57], v[12:13], v[248:249] op_sel_hi:[1,0,1]
    v_pk_fma_f32 v[218:219], v[42:43], v[12:13], v[218:219] op_sel_hi:[1,0,1]
    v_pk_fma_f32 v[250:251], v[58:59], v[12:13], v[250:251] op_sel_hi:[1,0,1]
    v_pk_fma_f32 v[220:221], v[44:45], v[12:13], v[220:221] op_sel_hi:[1,0,1]
    v_pk_fma_f32 v[252:253], v[60:61], v[12:13], v[252:253] op_sel_hi:[1,0,1]
    v_pk_fma_f32 v[222:223], v[46:47], v[12:13], v[222:223] op_sel_hi:[1,0,1]
    v_pk_fma_f32 v[254:255], v[62:63], v[12:13], v[254:255] op_sel_hi:[1,0,1]
    v_pk_mul_f32 v[18:19], v[208:209], v[16:17] op_sel:[0,1] op_sel_hi:[1,1]
    v_pk_mul_f32 v[20:21], v[210:211], v[16:17] op_sel:[0,1] op_sel_hi:[1,1]
    v_pk_mul_f32 v[22:23], v[212:213], v[16:17] op_sel:[0,1] op_sel_hi:[1,1]
    v_pk_mul_f32 v[24:25], v[214:215], v[16:17] op_sel:[0,1] op_sel_hi:[1,1]
    v_pk_mul_f32 v[208:209], v[208:209], v[16:17] op_sel_hi:[1,0]
    v_pk_mul_f32 v[210:211], v[210:211], v[16:17] op_sel_hi:[1,0]
    v_pk_mul_f32 v[212:213], v[212:213], v[16:17] op_sel_hi:[1,0]
    v_pk_mul_f32 v[214:215], v[214:215], v[16:17] op_sel_hi:[1,0]
    v_exp_f32 v18, v18
    v_exp_f32 v19, v19
    v_exp_f32 v20, v20
    v_exp_f32 v21, v21
    v_exp_f32 v22, v22
    v_exp_f32 v23, v23
    v_exp_f32 v24, v24
    v_exp_f32 v25, v25
    v_pk_mul_f32 v[240:241], v[240:241], v[16:17] op_sel_hi:[1,0]
    v_pk_mul_f32 v[242:243], v[242:243], v[16:17] op_sel_hi:[1,0]
    v_pk_mul_f32 v[244:245], v[244:245], v[16:17] op_sel_hi:[1,0]
    v_pk_mul_f32 v[246:247], v[246:247], v[16:17] op_sel_hi:[1,0]
    v_pk_add_f32 v[18:19], v[18:19], 1.0 op_sel_hi:[1,0]
    v_pk_add_f32 v[20:21], v[20:21], 1.0 op_sel_hi:[1,0]
    v_pk_add_f32 v[22:23], v[22:23], 1.0 op_sel_hi:[1,0]
    v_pk_add_f32 v[24:25], v[24:25], 1.0 op_sel_hi:[1,0]
    v_pk_mul_f32 v[240:241], v[240:241], v[208:209]
    v_pk_mul_f32 v[242:243], v[242:243], v[210:211]
    v_pk_mul_f32 v[244:245], v[244:245], v[212:213]
    v_pk_mul_f32 v[246:247], v[246:247], v[214:215]
    v_rcp_f32 v18, v18
    v_rcp_f32 v19, v19
    v_rcp_f32 v20, v20
    v_rcp_f32 v21, v21
    v_rcp_f32 v22, v22
    v_rcp_f32 v23, v23
    v_rcp_f32 v24, v24
    v_rcp_f32 v25, v25
    s_add_u32 s31, s60, 0
    s_lshl_b32 s31, s31, 10
    s_add_u32 s31, s31, s57
    v_pk_mul_f32 v[240:241], v[240:241], v[18:19]
    v_pk_mul_f32 v[242:243], v[242:243], v[20:21]
    v_pk_mul_f32 v[244:245], v[244:245], v[22:23]
    v_pk_mul_f32 v[246:247], v[246:247], v[24:25]
    v_cvt_pk_bf16_f32 v208, v240, v241
    v_cvt_pk_bf16_f32 v209, v242, v243
    v_cvt_pk_bf16_f32 v210, v244, v245
    v_cvt_pk_bf16_f32 v211, v246, v247
    buffer_store_dwordx4 v[208:211], v31, s[24:27], s31 offen sc1
    v_pk_mul_f32 v[18:19], v[216:217], v[16:17] op_sel:[0,1] op_sel_hi:[1,1]
    v_pk_mul_f32 v[20:21], v[218:219], v[16:17] op_sel:[0,1] op_sel_hi:[1,1]
    v_pk_mul_f32 v[22:23], v[220:221], v[16:17] op_sel:[0,1] op_sel_hi:[1,1]
    v_pk_mul_f32 v[24:25], v[222:223], v[16:17] op_sel:[0,1] op_sel_hi:[1,1]
    v_pk_mul_f32 v[216:217], v[216:217], v[16:17] op_sel_hi:[1,0]
    v_pk_mul_f32 v[218:219], v[218:219], v[16:17] op_sel_hi:[1,0]
    v_pk_mul_f32 v[220:221], v[220:221], v[16:17] op_sel_hi:[1,0]
    v_pk_mul_f32 v[222:223], v[222:223], v[16:17] op_sel_hi:[1,0]
    v_exp_f32 v18, v18
    v_exp_f32 v19, v19
    v_exp_f32 v20, v20
    v_exp_f32 v21, v21
    v_exp_f32 v22, v22
    v_exp_f32 v23, v23
    v_exp_f32 v24, v24
    v_exp_f32 v25, v25
    v_pk_mul_f32 v[248:249], v[248:249], v[16:17] op_sel_hi:[1,0]
    v_pk_mul_f32 v[250:251], v[250:251], v[16:17] op_sel_hi:[1,0]
    v_pk_mul_f32 v[252:253], v[252:253], v[16:17] op_sel_hi:[1,0]
    v_pk_mul_f32 v[254:255], v[254:255], v[16:17] op_sel_hi:[1,0]
    v_pk_add_f32 v[18:19], v[18:19], 1.0 op_sel_hi:[1,0]
    v_pk_add_f32 v[20:21], v[20:21], 1.0 op_sel_hi:[1,0]
    v_pk_add_f32 v[22:23], v[22:23], 1.0 op_sel_hi:[1,0]
    v_pk_add_f32 v[24:25], v[24:25], 1.0 op_sel_hi:[1,0]
    v_pk_mul_f32 v[248:249], v[248:249], v[216:217]
    v_pk_mul_f32 v[250:251], v[250:251], v[218:219]
    v_pk_mul_f32 v[252:253], v[252:253], v[220:221]
    v_pk_mul_f32 v[254:255], v[254:255], v[222:223]
    v_rcp_f32 v18, v18
    v_rcp_f32 v19, v19
    v_rcp_f32 v20, v20
    v_rcp_f32 v21, v21
    v_rcp_f32 v22, v22
    v_rcp_f32 v23, v23
    v_rcp_f32 v24, v24
    v_rcp_f32 v25, v25
    s_add_u32 s31, s60, 1
    s_lshl_b32 s31, s31, 10
    s_add_u32 s31, s31, s57
    v_pk_mul_f32 v[248:249], v[248:249], v[18:19]
    v_pk_mul_f32 v[250:251], v[250:251], v[20:21]
    v_pk_mul_f32 v[252:253], v[252:253], v[22:23]
    v_pk_mul_f32 v[254:255], v[254:255], v[24:25]
    v_cvt_pk_bf16_f32 v216, v248, v249
    v_cvt_pk_bf16_f32 v217, v250, v251
    v_cvt_pk_bf16_f32 v218, v252, v253
    v_cvt_pk_bf16_f32 v219, v254, v255
    buffer_store_dwordx4 v[216:219], v31, s[24:27], s31 offen sc1
    s_branch L_k1_done
L_k1_epi1:
    ds_read_b128 v[64:67], v5 offset:0
    ds_read_b128 v[68:71], v5 offset:32
    ds_read_b128 v[72:75], v5 offset:64
    ds_read_b128 v[76:79], v5 offset:96
    ds_read_b128 v[32:35], v5 offset:384
    ds_read_b128 v[36:39], v5 offset:416
    ds_read_b128 v[40:43], v5 offset:448
    ds_read_b128 v[44:47], v5 offset:480
    ds_read_b128 v[48:51], v5 offset:512
    ds_read_b128 v[52:55], v5 offset:544
    ds_read_b128 v[56:59], v5 offset:576
    ds_read_b128 v[60:63], v5 offset:608
    s_mul_i32 s58, s35, 48
    s_mul_i32 s31, s43, 24
    s_add_u32 s58, s58, s31
    s_add_u32 s58, s58, 128
    s_lshl_b32 s60, s35, 2
    s_lshl_b32 s31, s43, 1
    s_add_u32 s60, s60, s31
    s_add_u32 s60, s60, 64
    s_waitcnt lgkmcnt(0)
    v_pk_fma_f32 v[192:193], v[32:33], v[10:11], v[192:193] op_sel_hi:[1,0,1]
    v_pk_fma_f32 v[224:225], v[48:49], v[10:11], v[224:225] op_sel_hi:[1,0,1]
    v_pk_fma_f32 v[194:195], v[34:35], v[10:11], v[194:195] op_sel_hi:[1,0,1]
    v_pk_fma_f32 v[226:227], v[50:51], v[10:11], v[226:227] op_sel_hi:[1,0,1]
    v_pk_fma_f32 v[196:197], v[36:37], v[10:11], v[196:197] op_sel_hi:[1,0,1]
    v_pk_fma_f32 v[228:229], v[52:53], v[10:11], v[228:229] op_sel_hi:[1,0,1]
    v_pk_fma_f32 v[198:199], v[38:39], v[10:11], v[198:199] op_sel_hi:[1,0,1]
    v_pk_fma_f32 v[230:231], v[54:55], v[10:11], v[230:231] op_sel_hi:[1,0,1]
    v_pk_fma_f32 v[200:201], v[40:41], v[10:11], v[200:201] op_sel_hi:[1,0,1]
    v_pk_fma_f32 v[232:233], v[56:57], v[10:11], v[232:233] op_sel_hi:[1,0,1]
    v_pk_fma_f32 v[202:203], v[42:43], v[10:11], v[202:203] op_sel_hi:[1,0,1]
    v_pk_fma_f32 v[234:235], v[58:59], v[10:11], v[234:235] op_sel_hi:[1,0,1]
    v_pk_fma_f32 v[204:205], v[44:45], v[10:11], v[204:205] op_sel_hi:[1,0,1]
    v_pk_fma_f32 v[236:237], v[60:61], v[10:11], v[236:237] op_sel_hi:[1,0,1]
    v_pk_fma_f32 v[206:207], v[46:47], v[10:11], v[206:207] op_sel_hi:[1,0,1]
    v_pk_fma_f32 v[238:239], v[62:63], v[10:11], v[238:239] op_sel_hi:[1,0,1]
    v_pk_mul_f32 v[18:19], v[192:193], v[14:15] op_sel:[0,1] op_sel_hi:[1,1]
    v_pk_mul_f32 v[20:21], v[194:195], v[14:15] op_sel:[0,1] op_sel_hi:[1,1]
    v_pk_mul_f32 v[22:23], v[196:197], v[14:15] op_sel:[0,1] op_sel_hi:[1,1]
    v_pk_mul_f32 v[24:25], v[198:199], v[14:15] op_sel:[0,1] op_sel_hi:[1,1]
    v_pk_mul_f32 v[192:193], v[192:193], v[14:15] op_sel_hi:[1,0]
    v_pk_mul_f32 v[194:195], v[194:195], v[14:15] op_sel_hi:[1,0]
    v_pk_mul_f32 v[196:197], v[196:197], v[14:15] op_sel_hi:[1,0]
    v_pk_mul_f32 v[198:199], v[198:199], v[14:15] op_sel_hi:[1,0]
    v_exp_f32 v18, v18
    v_exp_f32 v19, v19
    v_exp_f32 v20, v20
    v_exp_f32 v21, v21
    v_exp_f32 v22, v22
    v_exp_f32 v23, v23
    v_exp_f32 v24, v24
    v_exp_f32 v25, v25
    v_pk_mul_f32 v[224:225], v[224:225], v[14:15] op_sel_hi:[1,0]
    v_pk_mul_f32 v[226:227], v[226:227], v[14:15] op_sel_hi:[1,0]
    v_pk_mul_f32 v[228:229], v[228:229], v[14:15] op_sel_hi:[1,0]
    v_pk_mul_f32 v[230:231], v[230:231], v[14:15] op_sel_hi:[1,0]
    v_pk_add_f32 v[18:19], v[18:19], 1.0 op_sel_hi:[1,0]
    v_pk_add_f32 v[20:21], v[20:21], 1.0 op_sel_hi:[1,0]
    v_pk_add_f32 v[22:23], v[22:23], 1.0 op_sel_hi:[1,0]
    v_pk_add_f32 v[24:25], v[24:25], 1.0 op_sel_hi:[1,0]
    v_pk_mul_f32 v[224:225], v[224:225], v[192:193]
    v_pk_mul_f32 v[226:227], v[226:227], v[194:195]
    v_pk_mul_f32 v[228:229], v[228:229], v[196:197]
    v_pk_mul_f32 v[230:231], v[230:231], v[198:199]
    v_rcp_f32 v18, v18
    v_rcp_f32 v19, v19
    v_rcp_f32 v20, v20
    v_rcp_f32 v21, v21
    v_rcp_f32 v22, v22
    v_rcp_f32 v23, v23
    v_rcp_f32 v24, v24
    v_rcp_f32 v25, v25
    s_add_u32 s31, s60, 0
    s_lshl_b32 s31, s31, 10
    s_add_u32 s31, s31, s56
    v_pk_mul_f32 v[224:225], v[224:225], v[18:19]
    v_pk_mul_f32 v[226:227], v[226:227], v[20:21]
    v_pk_mul_f32 v[228:229], v[228:229], v[22:23]
    v_pk_mul_f32 v[230:231], v[230:231], v[24:25]
    v_cvt_pk_bf16_f32 v192, v224, v225
    v_cvt_pk_bf16_f32 v193, v226, v227
    v_cvt_pk_bf16_f32 v194, v228, v229
    v_cvt_pk_bf16_f32 v195, v230, v231
    buffer_store_dwordx4 v[192:195], v31, s[24:27], s31 offen sc1
    v_pk_mul_f32 v[18:19], v[200:201], v[14:15] op_sel:[0,1] op_sel_hi:[1,1]
    v_pk_mul_f32 v[20:21], v[202:203], v[14:15] op_sel:[0,1] op_sel_hi:[1,1]
    v_pk_mul_f32 v[22:23], v[204:205], v[14:15] op_sel:[0,1] op_sel_hi:[1,1]
    v_pk_mul_f32 v[24:25], v[206:207], v[14:15] op_sel:[0,1] op_sel_hi:[1,1]
    v_pk_mul_f32 v[200:201], v[200:201], v[14:15] op_sel_hi:[1,0]
    v_pk_mul_f32 v[202:203], v[202:203], v[14:15] op_sel_hi:[1,0]
    v_pk_mul_f32 v[204:205], v[204:205], v[14:15] op_sel_hi:[1,0]
    v_pk_mul_f32 v[206:207], v[206:207], v[14:15] op_sel_hi:[1,0]
    v_exp_f32 v18, v18
    v_exp_f32 v19, v19
    v_exp_f32 v20, v20
    v_exp_f32 v21, v21
    v_exp_f32 v22, v22
    v_exp_f32 v23, v23
    v_exp_f32 v24, v24
    v_exp_f32 v25, v25
    v_pk_mul_f32 v[232:233], v[232:233], v[14:15] op_sel_hi:[1,0]
    v_pk_mul_f32 v[234:235], v[234:235], v[14:15] op_sel_hi:[1,0]
    v_pk_mul_f32 v[236:237], v[236:237], v[14:15] op_sel_hi:[1,0]
    v_pk_mul_f32 v[238:239], v[238:239], v[14:15] op_sel_hi:[1,0]
    v_pk_add_f32 v[18:19], v[18:19], 1.0 op_sel_hi:[1,0]
    v_pk_add_f32 v[20:21], v[20:21], 1.0 op_sel_hi:[1,0]
    v_pk_add_f32 v[22:23], v[22:23], 1.0 op_sel_hi:[1,0]
    v_pk_add_f32 v[24:25], v[24:25], 1.0 op_sel_hi:[1,0]
    v_pk_mul_f32 v[232:233], v[232:233], v[200:201]
    v_pk_mul_f32 v[234:235], v[234:235], v[202:203]
    v_pk_mul_f32 v[236:237], v[236:237], v[204:205]
    v_pk_mul_f32 v[238:239], v[238:239], v[206:207]
    v_rcp_f32 v18, v18
    v_rcp_f32 v19, v19
    v_rcp_f32 v20, v20
    v_rcp_f32 v21, v21
    v_rcp_f32 v22, v22
    v_rcp_f32 v23, v23
    v_rcp_f32 v24, v24
    v_rcp_f32 v25, v25
    s_add_u32 s31, s60, 1
    s_lshl_b32 s31, s31, 10
    s_add_u32 s31, s31, s56
    v_pk_mul_f32 v[232:233], v[232:233], v[18:19]
    v_pk_mul_f32 v[234:235], v[234:235], v[20:21]
    v_pk_mul_f32 v[236:237], v[236:237], v[22:23]
    v_pk_mul_f32 v[238:239], v[238:239], v[24:25]
    v_cvt_pk_bf16_f32 v200, v232, v233
    v_cvt_pk_bf16_f32 v201, v234, v235
    v_cvt_pk_bf16_f32 v202, v236, v237
    v_cvt_pk_bf16_f32 v203, v238, v239
    buffer_store_dwordx4 v[200:203], v31, s[24:27], s31 offen sc1
    v_pk_fma_f32 v[208:209], v[32:33], v[12:13], v[208:209] op_sel_hi:[1,0,1]
    v_pk_fma_f32 v[240:241], v[48:49], v[12:13], v[240:241] op_sel_hi:[1,0,1]
    v_pk_fma_f32 v[210:211], v[34:35], v[12:13], v[210:211] op_sel_hi:[1,0,1]
    v_pk_fma_f32 v[242:243], v[50:51], v[12:13], v[242:243] op_sel_hi:[1,0,1]
    v_pk_fma_f32 v[212:213], v[36:37], v[12:13], v[212:213] op_sel_hi:[1,0,1]
    v_pk_fma_f32 v[244:245], v[52:53], v[12:13], v[244:245] op_sel_hi:[1,0,1]
    v_pk_fma_f32 v[214:215], v[38:39], v[12:13], v[214:215] op_sel_hi:[1,0,1]
    v_pk_fma_f32 v[246:247], v[54:55], v[12:13], v[246:247] op_sel_hi:[1,0,1]
    v_pk_fma_f32 v[216:217], v[40:41], v[12:13], v[216:217] op_sel_hi:[1,0,1]
    v_pk_fma_f32 v[248:249], v[56:57], v[12:13], v[248:249] op_sel_hi:[1,0,1]
    v_pk_fma_f32 v[218:219], v[42:43], v[12:13], v[218:219] op_sel_hi:[1,0,1]
    v_pk_fma_f32 v[250:251], v[58:59], v[12:13], v[250:251] op_sel_hi:[1,0,1]
    v_pk_fma_f32 v[220:221], v[44:45], v[12:13], v[220:221] op_sel_hi:[1,0,1]
    v_pk_fma_f32 v[252:253], v[60:61], v[12:13], v[252:253] op_sel_hi:[1,0,1]
    v_pk_fma_f32 v[222:223], v[46:47], v[12:13], v[222:223] op_sel_hi:[1,0,1]
    v_pk_fma_f32 v[254:255], v[62:63], v[12:13], v[254:255] op_sel_hi:[1,0,1]
    v_pk_mul_f32 v[18:19], v[208:209], v[16:17] op_sel:[0,1] op_sel_hi:[1,1]
    v_pk_mul_f32 v[20:21], v[210:211], v[16:17] op_sel:[0,1] op_sel_hi:[1,1]
    v_pk_mul_f32 v[22:23], v[212:213], v[16:17] op_sel:[0,1] op_sel_hi:[1,1]
    v_pk_mul_f32 v[24:25], v[214:215], v[16:17] op_sel:[0,1] op_sel_hi:[1,1]
    v_pk_mul_f32 v[208:209], v[208:209], v[16:17] op_sel_hi:[1,0]
    v_pk_mul_f32 v[210:211], v[210:211], v[16:17] op_sel_hi:[1,0]
    v_pk_mul_f32 v[212:213], v[212:213], v[16:17] op_sel_hi:[1,0]
    v_pk_mul_f32 v[214:215], v[214:215], v[16:17] op_sel_hi:[1,0]
    v_exp_f32 v18, v18
    v_exp_f32 v19, v19
    v_exp_f32 v20, v20
    v_exp_f32 v21, v21
    v_exp_f32 v22, v22
    v_exp_f32 v23, v23
    v_exp_f32 v24, v24
    v_exp_f32 v25, v25
    v_pk_mul_f32 v[240:241], v[240:241], v[16:17] op_sel_hi:[1,0]
    v_pk_mul_f32 v[242:243], v[242:243], v[16:17] op_sel_hi:[1,0]
    v_pk_mul_f32 v[244:245], v[244:245], v[16:17] op_sel_hi:[1,0]
    v_pk_mul_f32 v[246:247], v[246:247], v[16:17] op_sel_hi:[1,0]
    v_pk_add_f32 v[18:19], v[18:19], 1.0 op_sel_hi:[1,0]
    v_pk_add_f32 v[20:21], v[20:21], 1.0 op_sel_hi:[1,0]
    v_pk_add_f32 v[22:23], v[22:23], 1.0 op_sel_hi:[1,0]
    v_pk_add_f32 v[24:25], v[24:25], 1.0 op_sel_hi:[1,0]
    v_pk_mul_f32 v[240:241], v[240:241], v[208:209]
    v_pk_mul_f32 v[242:243], v[242:243], v[210:211]
    v_pk_mul_f32 v[244:245], v[244:245], v[212:213]
    v_pk_mul_f32 v[246:247], v[246:247], v[214:215]
    v_rcp_f32 v18, v18
    v_rcp_f32 v19, v19
    v_rcp_f32 v20, v20
    v_rcp_f32 v21, v21
    v_rcp_f32 v22, v22
    v_rcp_f32 v23, v23
    v_rcp_f32 v24, v24
    v_rcp_f32 v25, v25
    s_add_u32 s31, s60, 0
    s_lshl_b32 s31, s31, 10
    s_add_u32 s31, s31, s57
    v_pk_mul_f32 v[240:241], v[240:241], v[18:19]
    v_pk_mul_f32 v[242:243], v[242:243], v[20:21]
    v_pk_mul_f32 v[244:245], v[244:245], v[22:23]
    v_pk_mul_f32 v[246:247], v[246:247], v[24:25]
    v_cvt_pk_bf16_f32 v208, v240, v241
    v_cvt_pk_bf16_f32 v209, v242, v243
    v_cvt_pk_bf16_f32 v210, v244, v245
    v_cvt_pk_bf16_f32 v211, v246, v247
    buffer_store_dwordx4 v[208:211], v31, s[24:27], s31 offen sc1
    v_pk_mul_f32 v[18:19], v[216:217], v[16:17] op_sel:[0,1] op_sel_hi:[1,1]
    v_pk_mul_f32 v[20:21], v[218:219], v[16:17] op_sel:[0,1] op_sel_hi:[1,1]
    v_pk_mul_f32 v[22:23], v[220:221], v[16:17] op_sel:[0,1] op_sel_hi:[1,1]
    v_pk_mul_f32 v[24:25], v[222:223], v[16:17] op_sel:[0,1] op_sel_hi:[1,1]
    v_pk_mul_f32 v[216:217], v[216:217], v[16:17] op_sel_hi:[1,0]
    v_pk_mul_f32 v[218:219], v[218:219], v[16:17] op_sel_hi:[1,0]
    v_pk_mul_f32 v[220:221], v[220:221], v[16:17] op_sel_hi:[1,0]
    v_pk_mul_f32 v[222:223], v[222:223], v[16:17] op_sel_hi:[1,0]
    v_exp_f32 v18, v18
    v_exp_f32 v19, v19
    v_exp_f32 v20, v20
    v_exp_f32 v21, v21
    v_exp_f32 v22, v22
    v_exp_f32 v23, v23
    v_exp_f32 v24, v24
    v_exp_f32 v25, v25
    v_pk_mul_f32 v[248:249], v[248:249], v[16:17] op_sel_hi:[1,0]
    v_pk_mul_f32 v[250:251], v[250:251], v[16:17] op_sel_hi:[1,0]
    v_pk_mul_f32 v[252:253], v[252:253], v[16:17] op_sel_hi:[1,0]
    v_pk_mul_f32 v[254:255], v[254:255], v[16:17] op_sel_hi:[1,0]
    v_pk_add_f32 v[18:19], v[18:19], 1.0 op_sel_hi:[1,0]
    v_pk_add_f32 v[20:21], v[20:21], 1.0 op_sel_hi:[1,0]
    v_pk_add_f32 v[22:23], v[22:23], 1.0 op_sel_hi:[1,0]
    v_pk_add_f32 v[24:25], v[24:25], 1.0 op_sel_hi:[1,0]
    v_pk_mul_f32 v[248:249], v[248:249], v[216:217]
    v_pk_mul_f32 v[250:251], v[250:251], v[218:219]
    v_pk_mul_f32 v[252:253], v[252:253], v[220:221]
    v_pk_mul_f32 v[254:255], v[254:255], v[222:223]
    v_rcp_f32 v18, v18
    v_rcp_f32 v19, v19
    v_rcp_f32 v20, v20
    v_rcp_f32 v21, v21
    v_rcp_f32 v22, v22
    v_rcp_f32 v23, v23
    v_rcp_f32 v24, v24
    v_rcp_f32 v25, v25
    s_add_u32 s31, s60, 1
    s_lshl_b32 s31, s31, 10
    s_add_u32 s31, s31, s57
    v_pk_mul_f32 v[248:249], v[248:249], v[18:19]
    v_pk_mul_f32 v[250:251], v[250:251], v[20:21]
    v_pk_mul_f32 v[252:253], v[252:253], v[22:23]
    v_pk_mul_f32 v[254:255], v[254:255], v[24:25]
    v_cvt_pk_bf16_f32 v216, v248, v249
    v_cvt_pk_bf16_f32 v217, v250, v251
    v_cvt_pk_bf16_f32 v218, v252, v253
    v_cvt_pk_bf16_f32 v219, v254, v255
    buffer_store_dwordx4 v[216:219], v31, s[24:27], s31 offen sc1
    s_cmp_ge_u32 s58, 480
    s_cbranch_scc1 L_k1_done
    s_cmp_lt_u32 s58, 160
    s_cselect_b32 s59, 0x3ea52b5c, 1.0
    s_lshl_b32 s32, s58, 14
    v_mul_f32 v20, s59, v7
    v_mul_f32 v22, s59, v9
    v_pk_fma_f32 v[96:97], v[64:65], v[10:11], v[96:97] op_sel_hi:[1,0,1]
    v_pk_fma_f32 v[98:99], v[66:67], v[10:11], v[98:99] op_sel_hi:[1,0,1]
    v_pk_fma_f32 v[112:113], v[64:65], v[12:13], v[112:113] op_sel_hi:[1,0,1]
    v_pk_fma_f32 v[114:115], v[66:67], v[12:13], v[114:115] op_sel_hi:[1,0,1]
    v_pk_mul_f32 v[96:97], v[96:97], v[20:21] op_sel_hi:[1,0]
    v_pk_mul_f32 v[98:99], v[98:99], v[20:21] op_sel_hi:[1,0]
    v_pk_mul_f32 v[112:113], v[112:113], v[22:23] op_sel_hi:[1,0]
    v_pk_mul_f32 v[114:115], v[114:115], v[22:23] op_sel_hi:[1,0]
    v_cvt_pk_bf16_f32 v96, v96, v97
    v_cvt_pk_bf16_f32 v97, v98, v99
    v_cvt_pk_bf16_f32 v112, v112, v113
    v_cvt_pk_bf16_f32 v113, v114, v115
    s_add_u32 s31, s32, s54
    s_add_u32 s31, s31, 0
    buffer_store_dwordx2 v[96:97], v30, s[24:27], s31 offen sc1
    s_add_u32 s31, s32, s55
    s_add_u32 s31, s31, 0
    buffer_store_dwordx2 v[112:113], v30, s[24:27], s31 offen sc1
    v_pk_fma_f32 v[100:101], v[68:69], v[10:11], v[100:101] op_sel_hi:[1,0,1]
    v_pk_fma_f32 v[102:103], v[70:71], v[10:11], v[102:103] op_sel_hi:[1,0,1]
    v_pk_fma_f32 v[116:117], v[68:69], v[12:13], v[116:117] op_sel_hi:[1,0,1]
    v_pk_fma_f32 v[118:119], v[70:71], v[12:13], v[118:119] op_sel_hi:[1,0,1]
    v_pk_mul_f32 v[100:101], v[100:101], v[20:21] op_sel_hi:[1,0]
    v_pk_mul_f32 v[102:103], v[102:103], v[20:21] op_sel_hi:[1,0]
    v_pk_mul_f32 v[116:117], v[116:117], v[22:23] op_sel_hi:[1,0]
    v_pk_mul_f32 v[118:119], v[118:119], v[22:23] op_sel_hi:[1,0]
    v_cvt_pk_bf16_f32 v100, v100, v101
    v_cvt_pk_bf16_f32 v101, v102, v103
    v_cvt_pk_bf16_f32 v116, v116, v117
    v_cvt_pk_bf16_f32 v117, v118, v119
    s_add_u32 s31, s32, s54
    s_add_u32 s31, s31, 32768
    buffer_store_dwordx2 v[100:101], v30, s[24:27], s31 offen sc1
    s_add_u32 s31, s32, s55
    s_add_u32 s31, s31, 32768
    buffer_store_dwordx2 v[116:117], v30, s[24:27], s31 offen sc1
    v_pk_fma_f32 v[104:105], v[72:73], v[10:11], v[104:105] op_sel_hi:[1,0,1]
    v_pk_fma_f32 v[106:107], v[74:75], v[10:11], v[106:107] op_sel_hi:[1,0,1]
    v_pk_fma_f32 v[120:121], v[72:73], v[12:13], v[120:121] op_sel_hi:[1,0,1]
    v_pk_fma_f32 v[122:123], v[74:75], v[12:13], v[122:123] op_sel_hi:[1,0,1]
    v_pk_mul_f32 v[104:105], v[104:105], v[20:21] op_sel_hi:[1,0]
    v_pk_mul_f32 v[106:107], v[106:107], v[20:21] op_sel_hi:[1,0]
    v_pk_mul_f32 v[120:121], v[120:121], v[22:23] op_sel_hi:[1,0]
    v_pk_mul_f32 v[122:123], v[122:123], v[22:23] op_sel_hi:[1,0]
    v_cvt_pk_bf16_f32 v104, v104, v105
    v_cvt_pk_bf16_f32 v105, v106, v107
    v_cvt_pk_bf16_f32 v120, v120, v121
    v_cvt_pk_bf16_f32 v121, v122, v123
    s_add_u32 s31, s32, s54
    s_add_u32 s31, s31, 65536
    buffer_store_dwordx2 v[104:105], v30, s[24:27], s31 offen sc1
    s_add_u32 s31, s32, s55
    s_add_u32 s31, s31, 65536
    buffer_store_dwordx2 v[120:121], v30, s[24:27], s31 offen sc1
    v_pk_fma_f32 v[108:109], v[76:77], v[10:11], v[108:109] op_sel_hi:[1,0,1]
    v_pk_fma_f32 v[110:111], v[78:79], v[10:11], v[110:111] op_sel_hi:[1,0,1]
    v_pk_fma_f32 v[124:125], v[76:77], v[12:13], v[124:125] op_sel_hi:[1,0,1]
    v_pk_fma_f32 v[126:127], v[78:79], v[12:13], v[126:127] op_sel_hi:[1,0,1]
    v_pk_mul_f32 v[108:109], v[108:109], v[20:21] op_sel_hi:[1,0]
    v_pk_mul_f32 v[110:111], v[110:111], v[20:21] op_sel_hi:[1,0]
    v_pk_mul_f32 v[124:125], v[124:125], v[22:23] op_sel_hi:[1,0]
    v_pk_mul_f32 v[126:127], v[126:127], v[22:23] op_sel_hi:[1,0]
    v_cvt_pk_bf16_f32 v108, v108, v109
    v_cvt_pk_bf16_f32 v109, v110, v111
    v_cvt_pk_bf16_f32 v124, v124, v125
    v_cvt_pk_bf16_f32 v125, v126, v127
    s_add_u32 s31, s32, s54
    s_add_u32 s31, s31, 98304
    buffer_store_dwordx2 v[108:109], v30, s[24:27], s31 offen sc1
    s_add_u32 s31, s32, s55
    s_add_u32 s31, s31, 98304
    buffer_store_dwordx2 v[124:125], v30, s[24:27], s31 offen sc1
    s_add_u32 s58, s58, 8
    s_cmp_ge_u32 s58, 480
    s_cbranch_scc1 L_k1_done
    ds_read_b128 v[64:67], v5 offset:128
    ds_read_b128 v[68:71], v5 offset:160
    ds_read_b128 v[72:75], v5 offset:192
    ds_read_b128 v[76:79], v5 offset:224
    s_waitcnt lgkmcnt(0)
    s_cmp_lt_u32 s58, 160
    s_cselect_b32 s59, 0x3ea52b5c, 1.0
    s_lshl_b32 s32, s58, 14
    v_mul_f32 v20, s59, v7
    v_mul_f32 v22, s59, v9
    v_pk_fma_f32 v[128:129], v[64:65], v[10:11], v[128:129] op_sel_hi:[1,0,1]
    v_pk_fma_f32 v[130:131], v[66:67], v[10:11], v[130:131] op_sel_hi:[1,0,1]
    v_pk_fma_f32 v[144:145], v[64:65], v[12:13], v[144:145] op_sel_hi:[1,0,1]
    v_pk_fma_f32 v[146:147], v[66:67], v[12:13], v[146:147] op_sel_hi:[1,0,1]
    v_pk_mul_f32 v[128:129], v[128:129], v[20:21] op_sel_hi:[1,0]
    v_pk_mul_f32 v[130:131], v[130:131], v[20:21] op_sel_hi:[1,0]
    v_pk_mul_f32 v[144:145], v[144:145], v[22:23] op_sel_hi:[1,0]
    v_pk_mul_f32 v[146:147], v[146:147], v[22:23] op_sel_hi:[1,0]
    v_cvt_pk_bf16_f32 v128, v128, v129
    v_cvt_pk_bf16_f32 v129, v130, v131
    v_cvt_pk_bf16_f32 v144, v144, v145
    v_cvt_pk_bf16_f32 v145, v146, v147
    s_add_u32 s31, s32, s54
    s_add_u32 s31, s31, 0
    buffer_store_dwordx2 v[128:129], v30, s[24:27], s31 offen sc1
    s_add_u32 s31, s32, s55
    s_add_u32 s31, s31, 0
    buffer_store_dwordx2 v[144:145], v30, s[24:27], s31 offen sc1
    v_pk_fma_f32 v[132:133], v[68:69], v[10:11], v[132:133] op_sel_hi:[1,0,1]
    v_pk_fma_f32 v[134:135], v[70:71], v[10:11], v[134:135] op_sel_hi:[1,0,1]
    v_pk_fma_f32 v[148:149], v[68:69], v[12:13], v[148:149] op_sel_hi:[1,0,1]
    v_pk_fma_f32 v[150:151], v[70:71], v[12:13], v[150:151] op_sel_hi:[1,0,1]
    v_pk_mul_f32 v[132:133], v[132:133], v[20:21] op_sel_hi:[1,0]
    v_pk_mul_f32 v[134:135], v[134:135], v[20:21] op_sel_hi:[1,0]
    v_pk_mul_f32 v[148:149], v[148:149], v[22:23] op_sel_hi:[1,0]
    v_pk_mul_f32 v[150:151], v[150:151], v[22:23] op_sel_hi:[1,0]
    v_cvt_pk_bf16_f32 v132, v132, v133
    v_cvt_pk_bf16_f32 v133, v134, v135
    v_cvt_pk_bf16_f32 v148, v148, v149
    v_cvt_pk_bf16_f32 v149, v150, v151
    s_add_u32 s31, s32, s54
    s_add_u32 s31, s31, 32768
    buffer_store_dwordx2 v[132:133], v30, s[24:27], s31 offen sc1
    s_add_u32 s31, s32, s55
    s_add_u32 s31, s31, 32768
    buffer_store_dwordx2 v[148:149], v30, s[24:27], s31 offen sc1
    v_pk_fma_f32 v[136:137], v[72:73], v[10:11], v[136:137] op_sel_hi:[1,0,1]
    v_pk_fma_f32 v[138:139], v[74:75], v[10:11], v[138:139] op_sel_hi:[1,0,1]
    v_pk_fma_f32 v[152:153], v[72:73], v[12:13], v[152:153] op_sel_hi:[1,0,1]
    v_pk_fma_f32 v[154:155], v[74:75], v[12:13], v[154:155] op_sel_hi:[1,0,1]
    v_pk_mul_f32 v[136:137], v[136:137], v[20:21] op_sel_hi:[1,0]
    v_pk_mul_f32 v[138:139], v[138:139], v[20:21] op_sel_hi:[1,0]
    v_pk_mul_f32 v[152:153], v[152:153], v[22:23] op_sel_hi:[1,0]
    v_pk_mul_f32 v[154:155], v[154:155], v[22:23] op_sel_hi:[1,0]
    v_cvt_pk_bf16_f32 v136, v136, v137
    v_cvt_pk_bf16_f32 v137, v138, v139
    v_cvt_pk_bf16_f32 v152, v152, v153
    v_cvt_pk_bf16_f32 v153, v154, v155
    s_add_u32 s31, s32, s54
    s_add_u32 s31, s31, 65536
    buffer_store_dwordx2 v[136:137], v30, s[24:27], s31 offen sc1
    s_add_u32 s31, s32, s55
    s_add_u32 s31, s31, 65536
    buffer_store_dwordx2 v[152:153], v30, s[24:27], s31 offen sc1
    v_pk_fma_f32 v[140:141], v[76:77], v[10:11], v[140:141] op_sel_hi:[1,0,1]
    v_pk_fma_f32 v[142:143], v[78:79], v[10:11], v[142:143] op_sel_hi:[1,0,1]
    v_pk_fma_f32 v[156:157], v[76:77], v[12:13], v[156:157] op_sel_hi:[1,0,1]
    v_pk_fma_f32 v[158:159], v[78:79], v[12:13], v[158:159] op_sel_hi:[1,0,1]
    v_pk_mul_f32 v[140:141], v[140:141], v[20:21] op_sel_hi:[1,0]
    v_pk_mul_f32 v[142:143], v[142:143], v[20:21] op_sel_hi:[1,0]
    v_pk_mul_f32 v[156:157], v[156:157], v[22:23] op_sel_hi:[1,0]
    v_pk_mul_f32 v[158:159], v[158:159], v[22:23] op_sel_hi:[1,0]
    v_cvt_pk_bf16_f32 v140, v140, v141
    v_cvt_pk_bf16_f32 v141, v142, v143
    v_cvt_pk_bf16_f32 v156, v156, v157
    v_cvt_pk_bf16_f32 v157, v158, v159
    s_add_u32 s31, s32, s54
    s_add_u32 s31, s31, 98304
    buffer_store_dwordx2 v[140:141], v30, s[24:27], s31 offen sc1
    s_add_u32 s31, s32, s55
    s_add_u32 s31, s31, 98304
    buffer_store_dwordx2 v[156:157], v30, s[24:27], s31 offen sc1
    s_add_u32 s58, s58, 8
    s_cmp_ge_u32 s58, 480
    s_cbranch_scc1 L_k1_done
    ds_read_b128 v[64:67], v5 offset:256
    ds_read_b128 v[68:71], v5 offset:288
    ds_read_b128 v[72:75], v5 offset:320
    ds_read_b128 v[76:79], v5 offset:352
    s_waitcnt lgkmcnt(0)
    s_cmp_lt_u32 s58, 160
    s_cselect_b32 s59, 0x3ea52b5c, 1.0
    s_lshl_b32 s32, s58, 14
    v_mul_f32 v20, s59, v7
    v_mul_f32 v22, s59, v9
    v_pk_fma_f32 v[160:161], v[64:65], v[10:11], v[160:161] op_sel_hi:[1,0,1]
    v_pk_fma_f32 v[162:163], v[66:67], v[10:11], v[162:163] op_sel_hi:[1,0,1]
    v_pk_fma_f32 v[176:177], v[64:65], v[12:13], v[176:177] op_sel_hi:[1,0,1]
    v_pk_fma_f32 v[178:179], v[66:67], v[12:13], v[178:179] op_sel_hi:[1,0,1]
    v_pk_mul_f32 v[160:161], v[160:161], v[20:21] op_sel_hi:[1,0]
    v_pk_mul_f32 v[162:163], v[162:163], v[20:21] op_sel_hi:[1,0]
    v_pk_mul_f32 v[176:177], v[176:177], v[22:23] op_sel_hi:[1,0]
    v_pk_mul_f32 v[178:179], v[178:179], v[22:23] op_sel_hi:[1,0]
    v_cvt_pk_bf16_f32 v160, v160, v161
    v_cvt_pk_bf16_f32 v161, v162, v163
    v_cvt_pk_bf16_f32 v176, v176, v177
    v_cvt_pk_bf16_f32 v177, v178, v179
    s_add_u32 s31, s32, s54
    s_add_u32 s31, s31, 0
    buffer_store_dwordx2 v[160:161], v30, s[24:27], s31 offen sc1
    s_add_u32 s31, s32, s55
    s_add_u32 s31, s31, 0
    buffer_store_dwordx2 v[176:177], v30, s[24:27], s31 offen sc1
    v_pk_fma_f32 v[164:165], v[68:69], v[10:11], v[164:165] op_sel_hi:[1,0,1]
    v_pk_fma_f32 v[166:167], v[70:71], v[10:11], v[166:167] op_sel_hi:[1,0,1]
    v_pk_fma_f32 v[180:181], v[68:69], v[12:13], v[180:181] op_sel_hi:[1,0,1]
    v_pk_fma_f32 v[182:183], v[70:71], v[12:13], v[182:183] op_sel_hi:[1,0,1]
    v_pk_mul_f32 v[164:165], v[164:165], v[20:21] op_sel_hi:[1,0]
    v_pk_mul_f32 v[166:167], v[166:167], v[20:21] op_sel_hi:[1,0]
    v_pk_mul_f32 v[180:181], v[180:181], v[22:23] op_sel_hi:[1,0]
    v_pk_mul_f32 v[182:183], v[182:183], v[22:23] op_sel_hi:[1,0]
    v_cvt_pk_bf16_f32 v164, v164, v165
    v_cvt_pk_bf16_f32 v165, v166, v167
    v_cvt_pk_bf16_f32 v180, v180, v181
    v_cvt_pk_bf16_f32 v181, v182, v183
    s_add_u32 s31, s32, s54
    s_add_u32 s31, s31, 32768
    buffer_store_dwordx2 v[164:165], v30, s[24:27], s31 offen sc1
    s_add_u32 s31, s32, s55
    s_add_u32 s31, s31, 32768
    buffer_store_dwordx2 v[180:181], v30, s[24:27], s31 offen sc1
    v_pk_fma_f32 v[168:169], v[72:73], v[10:11], v[168:169] op_sel_hi:[1,0,1]
    v_pk_fma_f32 v[170:171], v[74:75], v[10:11], v[170:171] op_sel_hi:[1,0,1]
    v_pk_fma_f32 v[184:185], v[72:73], v[12:13], v[184:185] op_sel_hi:[1,0,1]
    v_pk_fma_f32 v[186:187], v[74:75], v[12:13], v[186:187] op_sel_hi:[1,0,1]
    v_pk_mul_f32 v[168:169], v[168:169], v[20:21] op_sel_hi:[1,0]
    v_pk_mul_f32 v[170:171], v[170:171], v[20:21] op_sel_hi:[1,0]
    v_pk_mul_f32 v[184:185], v[184:185], v[22:23] op_sel_hi:[1,0]
    v_pk_mul_f32 v[186:187], v[186:187], v[22:23] op_sel_hi:[1,0]
    v_cvt_pk_bf16_f32 v168, v168, v169
    v_cvt_pk_bf16_f32 v169, v170, v171
    v_cvt_pk_bf16_f32 v184, v184, v185
    v_cvt_pk_bf16_f32 v185, v186, v187
    s_add_u32 s31, s32, s54
    s_add_u32 s31, s31, 65536
    buffer_store_dwordx2 v[168:169], v30, s[24:27], s31 offen sc1
    s_add_u32 s31, s32, s55
    s_add_u32 s31, s31, 65536
    buffer_store_dwordx2 v[184:185], v30, s[24:27], s31 offen sc1
    v_pk_fma_f32 v[172:173], v[76:77], v[10:11], v[172:173] op_sel_hi:[1,0,1]
    v_pk_fma_f32 v[174:175], v[78:79], v[10:11], v[174:175] op_sel_hi:[1,0,1]
    v_pk_fma_f32 v[188:189], v[76:77], v[12:13], v[188:189] op_sel_hi:[1,0,1]
    v_pk_fma_f32 v[190:191], v[78:79], v[12:13], v[190:191] op_sel_hi:[1,0,1]
    v_pk_mul_f32 v[172:173], v[172:173], v[20:21] op_sel_hi:[1,0]
    v_pk_mul_f32 v[174:175], v[174:175], v[20:21] op_sel_hi:[1,0]
    v_pk_mul_f32 v[188:189], v[188:189], v[22:23] op_sel_hi:[1,0]
    v_pk_mul_f32 v[190:191], v[190:191], v[22:23] op_sel_hi:[1,0]
    v_cvt_pk_bf16_f32 v172, v172, v173
    v_cvt_pk_bf16_f32 v173, v174, v175
    v_cvt_pk_bf16_f32 v188, v188, v189
    v_cvt_pk_bf16_f32 v189, v190, v191
    s_add_u32 s31, s32, s54
    s_add_u32 s31, s31, 98304
    buffer_store_dwordx2 v[172:173], v30, s[24:27], s31 offen sc1
    s_add_u32 s31, s32, s55
    s_add_u32 s31, s31, 98304
    buffer_store_dwordx2 v[188:189], v30, s[24:27], s31 offen sc1
    s_add_u32 s58, s58, 8
L_k1_done:
    s_endpgm
L_k1_loader:
    s_sub_u32 s42, s28, 4
    v_mov_b32 v10, 153856
    v_mov_b32 v11, 0
    ds_write_b32 v10, v11
    v_lshrrev_b32 v10, 3, v2
    v_mul_u32_u24 v10, 1280, v10
    v_and_b32 v11, 7, v2
    v_lshrrev_b32 v12, 4, v2
    v_xor_b32 v11, v11, v12
    v_lshl_add_u32 v3, v11, 4, v10
    v_xor_b32 v11, 4, v11
    v_lshl_add_u32 v4, v11, 4, v10
    s_lshl_b32 s31, s29, 7
    s_lshl_b32 s32, s42, 5
    s_add_u32 s31, s31, s32
    s_mul_i32 s43, s31, 1280
    s_lshl_b32 s46, s42, 12
    s_add_u32 s46, s46, 0
    s_mov_b32 s47, 0
    s_mov_b32 s48, 0
    s_mov_b32 s49, 0
    s_cmp_ge_u32 s29, 10
    s_cselect_b32 s31, 10, 0
    s_sub_u32 s51, s29, s31
    s_lshl_b32 s52, s51, 1
    s_lshl_b32 s31, s51, 7
    s_add_u32 s43, s43, s31
    s_and_b32 s53, s42, 1
    s_lshr_b32 s54, s42, 1
    s_cmp_ge_u32 s30, 8
    s_cbranch_scc1 L_k1_loader1
    v_lshrrev_b32 v10, 3, v2
    v_bfe_u32 v11, v10, 1, 1
    v_lshlrev_b32 v11, 2, v11
    v_and_b32 v12, 7, v2
    v_xor_b32 v12, v12, v11
    v_mul_u32_u24 v10, 3840, v10
    v_lshl_add_u32 v5, v12, 4, v10
    v_lshrrev_b32 v10, 4, v2
    v_lshlrev_b32 v11, 2, v10
    v_and_b32 v12, 15, v2
    v_xor_b32 v12, v12, v11
    v_mul_u32_u24 v10, 3072, v10
    v_lshl_add_u32 v8, v12, 4, v10
    s_mul_i32 s44, s42, 30720
    s_mul_i32 s45, s42, 24576
    s_lshl_b32 s31, s35, 7
    s_lshl_b32 s32, s35, 8
    s_add_u32 s44, s44, s31
    s_add_u32 s45, s45, s32
    s_mul_i32 s31, s52, 122880
    s_add_u32 s44, s44, s31
    s_mul_i32 s31, s52, 98304
    s_add_u32 s45, s45, s31
    s_mul_i32 s55, s42, 1024
    s_add_u32 s55, s55, 49152
    s_mul_i32 s56, s42, 2048
    s_add_u32 s56, s56, 53248
    s_add_u32 s57, s46, s47
    s_add_u32 m0, s57, 0
    s_add_u32 s31, s43, 0
    buffer_load_dwordx4 v3, s[8:11], s31 offen lds
    s_add_u32 m0, s57, 1024
    s_add_u32 s31, s43, 10240
    buffer_load_dwordx4 v4, s[8:11], s31 offen lds
    s_add_u32 m0, s57, 2048
    s_add_u32 s31, s43, 20480
    buffer_load_dwordx4 v3, s[8:11], s31 offen lds
    s_add_u32 m0, s57, 3072
    s_add_u32 s31, s43, 30720
    buffer_load_dwordx4 v4, s[8:11], s31 offen lds
    s_add_u32 s43, s43, 128
    s_add_u32 s51, s51, 1
    s_cmp_eq_u32 s51, 10
    s_cselect_b32 s31, 1280, 0
    s_cselect_b32 s51, 0, s51
    s_sub_u32 s43, s43, s31
    s_add_u32 s47, s47, 16384
    s_cmp_eq_u32 s47, 49152
    s_cselect_b32 s47, 0, s47
    s_add_u32 s57, s55, s48
    s_add_u32 s58, s56, s48
    s_add_u32 m0, s57, 0
    s_nop 0
    buffer_load_dwordx4 v5, s[12:15], s44 offen lds
    s_add_u32 m0, s58, 0
    s_add_u32 s31, s45, 0
    buffer_load_dwordx4 v8, s[16:19], s31 offen lds
    s_add_u32 m0, s58, 1024
    s_add_u32 s31, s45, 12288
    buffer_load_dwordx4 v8, s[16:19], s31 offen lds
    s_add_u32 m0, s58, 8192
    s_add_u32 s31, s45, 0
    buffer_load_dwordx4 v8, s[20:23], s31 offen lds
    s_add_u32 m0, s58, 9216
    s_add_u32 s31, s45, 12288
    buffer_load_dwordx4 v8, s[20:23], s31 offen lds
    s_add_u32 s44, s44, 122880
    s_add_u32 s45, s45, 98304
    s_add_u32 s52, s52, 1
    s_cmp_eq_u32 s52, 20
    s_cselect_b32 s31, 2457600, 0
    s_cselect_b32 s32, 1966080, 0
    s_cselect_b32 s52, 0, s52
    s_sub_u32 s44, s44, s31
    s_sub_u32 s45, s45, s32
    s_add_u32 s48, s48, 20480
    s_cmp_eq_u32 s48, 102400
    s_cselect_b32 s48, 0, s48
    s_waitcnt lgkmcnt(0)
    s_waitcnt vmcnt(0)
    s_barrier
    s_add_u32 s57, s55, s48
    s_add_u32 s58, s56, s48
    s_add_u32 m0, s57, 0
    s_nop 0
    buffer_load_dwordx4 v5, s[12:15], s44 offen lds
    s_add_u32 m0, s58, 0
    s_add_u32 s31, s45, 0
    buffer_load_dwordx4 v8, s[16:19], s31 offen lds
    s_add_u32 m0, s58, 1024
    s_add_u32 s31, s45, 12288
    buffer_load_dwordx4 v8, s[16:19], s31 offen lds
    s_add_u32 m0, s58, 8192
    s_add_u32 s31, s45, 0
    buffer_load_dwordx4 v8, s[20:23], s31 offen lds
    s_add_u32 m0, s58, 9216
    s_add_u32 s31, s45, 12288
    buffer_load_dwordx4 v8, s[20:23], s31 offen lds
    s_add_u32 s44, s44, 122880
    s_add_u32 s45, s45, 98304
    s_add_u32 s52, s52, 1
    s_cmp_eq_u32 s52, 20
    s_cselect_b32 s31, 2457600, 0
    s_cselect_b32 s32, 1966080, 0
    s_cselect_b32 s52, 0, s52
    s_sub_u32 s44, s44, s31
    s_sub_u32 s45, s45, s32
    s_add_u32 s48, s48, 20480
    s_cmp_eq_u32 s48, 102400
    s_cselect_b32 s48, 0, s48
    s_add_u32 s57, s46, s47
    s_add_u32 m0, s57, 0
    s_add_u32 s31, s43, 0
    buffer_load_dwordx4 v3, s[8:11], s31 offen lds
    s_add_u32 m0, s57, 1024
    s_add_u32 s31, s43, 10240
    buffer_load_dwordx4 v4, s[8:11], s31 offen lds
    s_add_u32 m0, s57, 2048
    s_add_u32 s31, s43, 20480
    buffer_load_dwordx4 v3, s[8:11], s31 offen lds
    s_add_u32 m0, s57, 3072
    s_add_u32 s31, s43, 30720
    buffer_load_dwordx4 v4, s[8:11], s31 offen lds
    s_add_u32 s43, s43, 128
    s_add_u32 s51, s51, 1
    s_cmp_eq_u32 s51, 10
    s_cselect_b32 s31, 1280, 0
    s_cselect_b32 s51, 0, s51
    s_sub_u32 s43, s43, s31
    s_add_u32 s47, s47, 16384
    s_cmp_eq_u32 s47, 49152
    s_cselect_b32 s47, 0, s47
    s_add_u32 s57, s55, s48
    s_add_u32 s58, s56, s48
    s_add_u32 m0, s57, 0
    s_nop 0
    buffer_load_dwordx4 v5, s[12:15], s44 offen lds
    s_add_u32 m0, s58, 0
    s_add_u32 s31, s45, 0
    buffer_load_dwordx4 v8, s[16:19], s31 offen lds
    s_add_u32 m0, s58, 1024
    s_add_u32 s31, s45, 12288
    buffer_load_dwordx4 v8, s[16:19], s31 offen lds
    s_add_u32 m0, s58, 8192
    s_add_u32 s31, s45, 0
    buffer_load_dwordx4 v8, s[20:23], s31 offen lds
    s_add_u32 m0, s58, 9216
    s_add_u32 s31, s45, 12288
    buffer_load_dwordx4 v8, s[20:23], s31 offen lds
    s_add_u32 s44, s44, 122880
    s_add_u32 s45, s45, 98304
    s_add_u32 s52, s52, 1
    s_cmp_eq_u32 s52, 20
    s_cselect_b32 s31, 2457600, 0
    s_cselect_b32 s32, 1966080, 0
    s_cselect_b32 s52, 0, s52
    s_sub_u32 s44, s44, s31
    s_sub_u32 s45, s45, s32
    s_add_u32 s48, s48, 20480
    s_cmp_eq_u32 s48, 102400
    s_cselect_b32 s48, 0, s48
    s_waitcnt vmcnt(9)
    s_barrier
    s_add_u32 s57, s55, s48
    s_add_u32 s58, s56, s48
    s_add_u32 m0, s57, 0
    s_nop 0
    buffer_load_dwordx4 v5, s[12:15], s44 offen lds
    s_add_u32 m0, s58, 0
    s_add_u32 s31, s45, 0
    buffer_load_dwordx4 v8, s[16:19], s31 offen lds
    s_add_u32 m0, s58, 1024
    s_add_u32 s31, s45, 12288
    buffer_load_dwordx4 v8, s[16:19], s31 offen lds
    s_add_u32 m0, s58, 8192
    s_add_u32 s31, s45, 0
    buffer_load_dwordx4 v8, s[20:23], s31 offen lds
    s_add_u32 m0, s58, 9216
    s_add_u32 s31, s45, 12288
    buffer_load_dwordx4 v8, s[20:23], s31 offen lds
    s_add_u32 s44, s44, 122880
    s_add_u32 s45, s45, 98304
    s_add_u32 s52, s52, 1
    s_cmp_eq_u32 s52, 20
    s_cselect_b32 s31, 2457600, 0
    s_cselect_b32 s32, 1966080, 0
    s_cselect_b32 s52, 0, s52
    s_sub_u32 s44, s44, s31
    s_sub_u32 s45, s45, s32
    s_add_u32 s48, s48, 20480
    s_cmp_eq_u32 s48, 102400
    s_cselect_b32 s48, 0, s48
    s_add_u32 s57, s46, s47
    s_add_u32 m0, s57, 0
    s_add_u32 s31, s43, 0
    buffer_load_dwordx4 v3, s[8:11], s31 offen lds
    s_add_u32 m0, s57, 1024
    s_add_u32 s31, s43, 10240
    buffer_load_dwordx4 v4, s[8:11], s31 offen lds
    s_add_u32 m0, s57, 2048
    s_add_u32 s31, s43, 20480
    buffer_load_dwordx4 v3, s[8:11], s31 offen lds
    s_add_u32 m0, s57, 3072
    s_add_u32 s31, s43, 30720
    buffer_load_dwordx4 v4, s[8:11], s31 offen lds
    s_add_u32 s43, s43, 128
    s_add_u32 s51, s51, 1
    s_cmp_eq_u32 s51, 10
    s_cselect_b32 s31, 1280, 0
    s_cselect_b32 s51, 0, s51
    s_sub_u32 s43, s43, s31
    s_add_u32 s47, s47, 16384
    s_cmp_eq_u32 s47, 49152
    s_cselect_b32 s47, 0, s47
    s_add_u32 s57, s55, s48
    s_add_u32 s58, s56, s48
    s_add_u32 m0, s57, 0
    s_nop 0
    buffer_load_dwordx4 v5, s[12:15], s44 offen lds
    s_add_u32 m0, s58, 0
    s_add_u32 s31, s45, 0
    buffer_load_dwordx4 v8, s[16:19], s31 offen lds
    s_add_u32 m0, s58, 1024
    s_add_u32 s31, s45, 12288
    buffer_load_dwordx4 v8, s[16:19], s31 offen lds
    s_add_u32 m0, s58, 8192
    s_add_u32 s31, s45, 0
    buffer_load_dwordx4 v8, s[20:23], s31 offen lds
    s_add_u32 m0, s58, 9216
    s_add_u32 s31, s45, 12288
    buffer_load_dwordx4 v8, s[20:23], s31 offen lds
    s_add_u32 s44, s44, 122880
    s_add_u32 s45, s45, 98304
    s_add_u32 s52, s52, 1
    s_cmp_eq_u32 s52, 20
    s_cselect_b32 s31, 2457600, 0
    s_cselect_b32 s32, 1966080, 0
    s_cselect_b32 s52, 0, s52
    s_sub_u32 s44, s44, s31
    s_sub_u32 s45, s45, s32
    s_add_u32 s48, s48, 20480
    s_cmp_eq_u32 s48, 102400
    s_cselect_b32 s48, 0, s48
    s_mov_b32 s50, 7
L_k1_lpairt0:
    s_waitcnt vmcnt(14)
    s_barrier
    s_add_u32 s57, s55, s48
    s_add_u32 s58, s56, s48
    s_add_u32 m0, s57, 0
    s_nop 0
    buffer_load_dwordx4 v5, s[12:15], s44 offen lds
    s_add_u32 m0, s58, 0
    s_add_u32 s31, s45, 0
    buffer_load_dwordx4 v8, s[16:19], s31 offen lds
    s_add_u32 m0, s58, 1024
    s_add_u32 s31, s45, 12288
    buffer_load_dwordx4 v8, s[16:19], s31 offen lds
    s_add_u32 m0, s58, 8192
    s_add_u32 s31, s45, 0
    buffer_load_dwordx4 v8, s[20:23], s31 offen lds
    s_add_u32 m0, s58, 9216
    s_add_u32 s31, s45, 12288
    buffer_load_dwordx4 v8, s[20:23], s31 offen lds
    s_add_u32 s44, s44, 122880
    s_add_u32 s45, s45, 98304
    s_add_u32 s52, s52, 1
    s_cmp_eq_u32 s52, 20
    s_cselect_b32 s31, 2457600, 0
    s_cselect_b32 s32, 1966080, 0
    s_cselect_b32 s52, 0, s52
    s_sub_u32 s44, s44, s31
    s_sub_u32 s45, s45, s32
    s_add_u32 s48, s48, 20480
    s_cmp_eq_u32 s48, 102400
    s_cselect_b32 s48, 0, s48
    s_waitcnt vmcnt(14)
    s_barrier
    s_add_u32 s57, s46, s47
    s_add_u32 m0, s57, 0
    s_add_u32 s31, s43, 0
    buffer_load_dwordx4 v3, s[8:11], s31 offen lds
    s_add_u32 m0, s57, 1024
    s_add_u32 s31, s43, 10240
    buffer_load_dwordx4 v4, s[8:11], s31 offen lds
    s_add_u32 m0, s57, 2048
    s_add_u32 s31, s43, 20480
    buffer_load_dwordx4 v3, s[8:11], s31 offen lds
    s_add_u32 m0, s57, 3072
    s_add_u32 s31, s43, 30720
    buffer_load_dwordx4 v4, s[8:11], s31 offen lds
    s_add_u32 s43, s43, 128
    s_add_u32 s51, s51, 1
    s_cmp_eq_u32 s51, 10
    s_cselect_b32 s31, 1280, 0
    s_cselect_b32 s51, 0, s51
    s_sub_u32 s43, s43, s31
    s_add_u32 s47, s47, 16384
    s_cmp_eq_u32 s47, 49152
    s_cselect_b32 s47, 0, s47
    s_add_u32 s57, s55, s48
    s_add_u32 s58, s56, s48
    s_add_u32 m0, s57, 0
    s_nop 0
    buffer_load_dwordx4 v5, s[12:15], s44 offen lds
    s_add_u32 m0, s58, 0
    s_add_u32 s31, s45, 0
    buffer_load_dwordx4 v8, s[16:19], s31 offen lds
    s_add_u32 m0, s58, 1024
    s_add_u32 s31, s45, 12288
    buffer_load_dwordx4 v8, s[16:19], s31 offen lds
    s_add_u32 m0, s58, 8192
    s_add_u32 s31, s45, 0
    buffer_load_dwordx4 v8, s[20:23], s31 offen lds
    s_add_u32 m0, s58, 9216
    s_add_u32 s31, s45, 12288
    buffer_load_dwordx4 v8, s[20:23], s31 offen lds
    s_add_u32 s44, s44, 122880
    s_add_u32 s45, s45, 98304
    s_add_u32 s52, s52, 1
    s_cmp_eq_u32 s52, 20
    s_cselect_b32 s31, 2457600, 0
    s_cselect_b32 s32, 1966080, 0
    s_cselect_b32 s52, 0, s52
    s_sub_u32 s44, s44, s31
    s_sub_u32 s45, s45, s32
    s_add_u32 s48, s48, 20480
    s_cmp_eq_u32 s48, 102400
    s_cselect_b32 s48, 0, s48
    s_sub_u32 s50, s50, 1
    s_cmp_lg_u32 s50, 0
    s_cbranch_scc1 L_k1_lpairt0
    s_waitcnt vmcnt(14)
    s_barrier
    s_add_u32 s57, s55, s48
    s_add_u32 s58, s56, s48
    s_add_u32 m0, s57, 0
    s_nop 0
    buffer_load_dwordx4 v5, s[12:15], s44 offen lds
    s_add_u32 m0, s58, 0
    s_add_u32 s31, s45, 0
    buffer_load_dwordx4 v8, s[16:19], s31 offen lds
    s_add_u32 m0, s58, 1024
    s_add_u32 s31, s45, 12288
    buffer_load_dwordx4 v8, s[16:19], s31 offen lds
    s_add_u32 m0, s58, 8192
    s_add_u32 s31, s45, 0
    buffer_load_dwordx4 v8, s[20:23], s31 offen lds
    s_add_u32 m0, s58, 9216
    s_add_u32 s31, s45, 12288
    buffer_load_dwordx4 v8, s[20:23], s31 offen lds
    s_add_u32 s44, s44, 122880
    s_add_u32 s45, s45, 98304
    s_add_u32 s52, s52, 1
    s_cmp_eq_u32 s52, 20
    s_cselect_b32 s31, 2457600, 0
    s_cselect_b32 s32, 1966080, 0
    s_cselect_b32 s52, 0, s52
    s_sub_u32 s44, s44, s31
    s_sub_u32 s45, s45, s32
    s_add_u32 s48, s48, 20480
    s_cmp_eq_u32 s48, 102400
    s_cselect_b32 s48, 0, s48
    s_branch L_k1_lsum
L_k1_loader1:
    v_add_u32 v10, 0, v2
    v_mul_u32_u24 v11, 43691, v10
    v_lshrrev_b32 v11, 20, v11
    v_mul_u32_u24 v12, 24, v11
    v_sub_u32 v12, v10, v12
    v_bfe_u32 v13, v11, 1, 1
    v_lshlrev_b32 v13, 2, v13
    v_xor_b32 v12, v12, v13
    v_mul_u32_u24 v11, 3840, v11
    v_lshl_add_u32 v5, v12, 4, v11
    v_add_u32 v10, 64, v2
    v_mul_u32_u24 v11, 43691, v10
    v_lshrrev_b32 v11, 20, v11
    v_mul_u32_u24 v12, 24, v11
    v_sub_u32 v12, v10, v12
    v_bfe_u32 v13, v11, 1, 1
    v_lshlrev_b32 v13, 2, v13
    v_xor_b32 v12, v12, v13
    v_mul_u32_u24 v11, 3840, v11
    v_lshl_add_u32 v6, v12, 4, v11
    v_add_u32 v10, 128, v2
    v_mul_u32_u24 v11, 43691, v10
    v_lshrrev_b32 v11, 20, v11
    v_mul_u32_u24 v12, 24, v11
    v_sub_u32 v12, v10, v12
    v_bfe_u32 v13, v11, 1, 1
    v_lshlrev_b32 v13, 2, v13
    v_xor_b32 v12, v12, v13
    v_mul_u32_u24 v11, 3840, v11
    v_lshl_add_u32 v7, v12, 4, v11
    v_lshrrev_b32 v10, 3, v2
    v_bfe_u32 v11, v10, 1, 1
    v_lshlrev_b32 v11, 2, v11
    v_and_b32 v12, 7, v2
    v_xor_b32 v12, v12, v11
    v_mul_u32_u24 v10, 3072, v10
    v_lshl_add_u32 v8, v12, 4, v10
    s_mul_i32 s44, s42, 30720
    s_mul_i32 s45, s42, 24576
    s_mul_i32 s31, s35, 384
    s_add_u32 s31, s31, 1024
    s_lshl_b32 s32, s35, 7
    s_add_u32 s32, s32, 2048
    s_add_u32 s44, s44, s31
    s_add_u32 s45, s45, s32
    s_mul_i32 s31, s52, 122880
    s_add_u32 s44, s44, s31
    s_mul_i32 s31, s52, 98304
    s_add_u32 s45, s45, s31
    s_mul_i32 s55, s42, 3072
    s_add_u32 s55, s55, 49152
    s_mul_i32 s56, s42, 1024
    s_add_u32 s56, s56, 61440
    s_add_u32 s57, s46, s47
    s_add_u32 m0, s57, 0
    s_add_u32 s31, s43, 0
    buffer_load_dwordx4 v3, s[8:11], s31 offen lds
    s_add_u32 m0, s57, 1024
    s_add_u32 s31, s43, 10240
    buffer_load_dwordx4 v4, s[8:11], s31 offen lds
    s_add_u32 m0, s57, 2048
    s_add_u32 s31, s43, 20480
    buffer_load_dwordx4 v3, s[8:11], s31 offen lds
    s_add_u32 m0, s57, 3072
    s_add_u32 s31, s43, 30720
    buffer_load_dwordx4 v4, s[8:11], s31 offen lds
    s_add_u32 s43, s43, 128
    s_add_u32 s51, s51, 1
    s_cmp_eq_u32 s51, 10
    s_cselect_b32 s31, 1280, 0
    s_cselect_b32 s51, 0, s51
    s_sub_u32 s43, s43, s31
    s_add_u32 s47, s47, 16384
    s_cmp_eq_u32 s47, 49152
    s_cselect_b32 s47, 0, s47
    s_add_u32 s57, s55, s48
    s_add_u32 s58, s56, s48
    s_add_u32 m0, s57, 0
    s_nop 0
    buffer_load_dwordx4 v5, s[12:15], s44 offen lds
    s_add_u32 m0, s57, 1024
    s_nop 0
    buffer_load_dwordx4 v6, s[12:15], s44 offen lds
    s_add_u32 m0, s57, 2048
    s_nop 0
    buffer_load_dwordx4 v7, s[12:15], s44 offen lds
    s_add_u32 m0, s58, 0
    s_add_u32 s31, s45, 0
    buffer_load_dwordx4 v8, s[16:19], s31 offen lds
    s_add_u32 m0, s58, 4096
    s_add_u32 s31, s45, 0
    buffer_load_dwordx4 v8, s[20:23], s31 offen lds
    s_add_u32 s44, s44, 122880
    s_add_u32 s45, s45, 98304
    s_add_u32 s52, s52, 1
    s_cmp_eq_u32 s52, 20
    s_cselect_b32 s31, 2457600, 0
    s_cselect_b32 s32, 1966080, 0
    s_cselect_b32 s52, 0, s52
    s_sub_u32 s44, s44, s31
    s_sub_u32 s45, s45, s32
    s_add_u32 s48, s48, 20480
    s_cmp_eq_u32 s48, 102400
    s_cselect_b32 s48, 0, s48
    s_waitcnt lgkmcnt(0)
    s_waitcnt vmcnt(0)
    s_barrier
    s_add_u32 s57, s55, s48
    s_add_u32 s58, s56, s48
    s_add_u32 m0, s57, 0
    s_nop 0
    buffer_load_dwordx4 v5, s[12:15], s44 offen lds
    s_add_u32 m0, s57, 1024
    s_nop 0
    buffer_load_dwordx4 v6, s[12:15], s44 offen lds
    s_add_u32 m0, s57, 2048
    s_nop 0
    buffer_load_dwordx4 v7, s[12:15], s44 offen lds
    s_add_u32 m0, s58, 0
    s_add_u32 s31, s45, 0
    buffer_load_dwordx4 v8, s[16:19], s31 offen lds
    s_add_u32 m0, s58, 4096
    s_add_u32 s31, s45, 0
    buffer_load_dwordx4 v8, s[20:23], s31 offen lds
    s_add_u32 s44, s44, 122880
    s_add_u32 s45, s45, 98304
    s_add_u32 s52, s52, 1
    s_cmp_eq_u32 s52, 20
    s_cselect_b32 s31, 2457600, 0
    s_cselect_b32 s32, 1966080, 0
    s_cselect_b32 s52, 0, s52
    s_sub_u32 s44, s44, s31
    s_sub_u32 s45, s45, s32
    s_add_u32 s48, s48, 20480
    s_cmp_eq_u32 s48, 102400
    s_cselect_b32 s48, 0, s48
    s_add_u32 s57, s46, s47
    s_add_u32 m0, s57, 0
    s_add_u32 s31, s43, 0
    buffer_load_dwordx4 v3, s[8:11], s31 offen lds
    s_add_u32 m0, s57, 1024
    s_add_u32 s31, s43, 10240
    buffer_load_dwordx4 v4, s[8:11], s31 offen lds
    s_add_u32 m0, s57, 2048
    s_add_u32 s31, s43, 20480
    buffer_load_dwordx4 v3, s[8:11], s31 offen lds
    s_add_u32 m0, s57, 3072
    s_add_u32 s31, s43, 30720
    buffer_load_dwordx4 v4, s[8:11], s31 offen lds
    s_add_u32 s43, s43, 128
    s_add_u32 s51, s51, 1
    s_cmp_eq_u32 s51, 10
    s_cselect_b32 s31, 1280, 0
    s_cselect_b32 s51, 0, s51
    s_sub_u32 s43, s43, s31
    s_add_u32 s47, s47, 16384
    s_cmp_eq_u32 s47, 49152
    s_cselect_b32 s47, 0, s47
    s_add_u32 s57, s55, s48
    s_add_u32 s58, s56, s48
    s_add_u32 m0, s57, 0
    s_nop 0
    buffer_load_dwordx4 v5, s[12:15], s44 offen lds
    s_add_u32 m0, s57, 1024
    s_nop 0
    buffer_load_dwordx4 v6, s[12:15], s44 offen lds
    s_add_u32 m0, s57, 2048
    s_nop 0
    buffer_load_dwordx4 v7, s[12:15], s44 offen lds
    s_add_u32 m0, s58, 0
    s_add_u32 s31, s45, 0
    buffer_load_dwordx4 v8, s[16:19], s31 offen lds
    s_add_u32 m0, s58, 4096
    s_add_u32 s31, s45, 0
    buffer_load_dwordx4 v8, s[20:23], s31 offen lds
    s_add_u32 s44, s44, 122880
    s_add_u32 s45, s45, 98304
    s_add_u32 s52, s52, 1
    s_cmp_eq_u32 s52, 20
    s_cselect_b32 s31, 2457600, 0
    s_cselect_b32 s32, 1966080, 0
    s_cselect_b32 s52, 0, s52
    s_sub_u32 s44, s44, s31
    s_sub_u32 s45, s45, s32
    s_add_u32 s48, s48, 20480
    s_cmp_eq_u32 s48, 102400
    s_cselect_b32 s48, 0, s48
    s_waitcnt vmcnt(9)
    s_barrier
    s_add_u32 s57, s55, s48
    s_add_u32 s58, s56, s48
    s_add_u32 m0, s57, 0
    s_nop 0
    buffer_load_dwordx4 v5, s[12:15], s44 offen lds
    s_add_u32 m0, s57, 1024
    s_nop 0
    buffer_load_dwordx4 v6, s[12:15], s44 offen lds
    s_add_u32 m0, s57, 2048
    s_nop 0
    buffer_load_dwordx4 v7, s[12:15], s44 offen lds
    s_add_u32 m0, s58, 0
    s_add_u32 s31, s45, 0
    buffer_load_dwordx4 v8, s[16:19], s31 offen lds
    s_add_u32 m0, s58, 4096
    s_add_u32 s31, s45, 0
    buffer_load_dwordx4 v8, s[20:23], s31 offen lds
    s_add_u32 s44, s44, 122880
    s_add_u32 s45, s45, 98304
    s_add_u32 s52, s52, 1
    s_cmp_eq_u32 s52, 20
    s_cselect_b32 s31, 2457600, 0
    s_cselect_b32 s32, 1966080, 0
    s_cselect_b32 s52, 0, s52
    s_sub_u32 s44, s44, s31
    s_sub_u32 s45, s45, s32
    s_add_u32 s48, s48, 20480
    s_cmp_eq_u32 s48, 102400
    s_cselect_b32 s48, 0, s48
    s_add_u32 s57, s46, s47
    s_add_u32 m0, s57, 0
    s_add_u32 s31, s43, 0
    buffer_load_dwordx4 v3, s[8:11], s31 offen lds
    s_add_u32 m0, s57, 1024
    s_add_u32 s31, s43, 10240
    buffer_load_dwordx4 v4, s[8:11], s31 offen lds
    s_add_u32 m0, s57, 2048
    s_add_u32 s31, s43, 20480
    buffer_load_dwordx4 v3, s[8:11], s31 offen lds
    s_add_u32 m0, s57, 3072
    s_add_u32 s31, s43, 30720
    buffer_load_dwordx4 v4, s[8:11], s31 offen lds
    s_add_u32 s43, s43, 128
    s_add_u32 s51, s51, 1
    s_cmp_eq_u32 s51, 10
    s_cselect_b32 s31, 1280, 0
    s_cselect_b32 s51, 0, s51
    s_sub_u32 s43, s43, s31
    s_add_u32 s47, s47, 16384
    s_cmp_eq_u32 s47, 49152
    s_cselect_b32 s47, 0, s47
    s_add_u32 s57, s55, s48
    s_add_u32 s58, s56, s48
    s_add_u32 m0, s57, 0
    s_nop 0
    buffer_load_dwordx4 v5, s[12:15], s44 offen lds
    s_add_u32 m0, s57, 1024
    s_nop 0
    buffer_load_dwordx4 v6, s[12:15], s44 offen lds
    s_add_u32 m0, s57, 2048
    s_nop 0
    buffer_load_dwordx4 v7, s[12:15], s44 offen lds
    s_add_u32 m0, s58, 0
    s_add_u32 s31, s45, 0
    buffer_load_dwordx4 v8, s[16:19], s31 offen lds
    s_add_u32 m0, s58, 4096
    s_add_u32 s31, s45, 0
    buffer_load_dwordx4 v8, s[20:23], s31 offen lds
    s_add_u32 s44, s44, 122880
    s_add_u32 s45, s45, 98304
    s_add_u32 s52, s52, 1
    s_cmp_eq_u32 s52, 20
    s_cselect_b32 s31, 2457600, 0
    s_cselect_b32 s32, 1966080, 0
    s_cselect_b32 s52, 0, s52
    s_sub_u32 s44, s44, s31
    s_sub_u32 s45, s45, s32
    s_add_u32 s48, s48, 20480
    s_cmp_eq_u32 s48, 102400
    s_cselect_b32 s48, 0, s48
    s_mov_b32 s50, 7
L_k1_lpairt1:
    s_waitcnt vmcnt(14)
    s_barrier
    s_add_u32 s57, s55, s48
    s_add_u32 s58, s56, s48
    s_add_u32 m0, s57, 0
    s_nop 0
    buffer_load_dwordx4 v5, s[12:15], s44 offen lds
    s_add_u32 m0, s57, 1024
    s_nop 0
    buffer_load_dwordx4 v6, s[12:15], s44 offen lds
    s_add_u32 m0, s57, 2048
    s_nop 0
    buffer_load_dwordx4 v7, s[12:15], s44 offen lds
    s_add_u32 m0, s58, 0
    s_add_u32 s31, s45, 0
    buffer_load_dwordx4 v8, s[16:19], s31 offen lds
    s_add_u32 m0, s58, 4096
    s_add_u32 s31, s45, 0
    buffer_load_dwordx4 v8, s[20:23], s31 offen lds
    s_add_u32 s44, s44, 122880
    s_add_u32 s45, s45, 98304
    s_add_u32 s52, s52, 1
    s_cmp_eq_u32 s52, 20
    s_cselect_b32 s31, 2457600, 0
    s_cselect_b32 s32, 1966080, 0
    s_cselect_b32 s52, 0, s52
    s_sub_u32 s44, s44, s31
    s_sub_u32 s45, s45, s32
    s_add_u32 s48, s48, 20480
    s_cmp_eq_u32 s48, 102400
    s_cselect_b32 s48, 0, s48
    s_waitcnt vmcnt(14)
    s_barrier
    s_add_u32 s57, s46, s47
    s_add_u32 m0, s57, 0
    s_add_u32 s31, s43, 0
    buffer_load_dwordx4 v3, s[8:11], s31 offen lds
    s_add_u32 m0, s57, 1024
    s_add_u32 s31, s43, 10240
    buffer_load_dwordx4 v4, s[8:11], s31 offen lds
    s_add_u32 m0, s57, 2048
    s_add_u32 s31, s43, 20480
    buffer_load_dwordx4 v3, s[8:11], s31 offen lds
    s_add_u32 m0, s57, 3072
    s_add_u32 s31, s43, 30720
    buffer_load_dwordx4 v4, s[8:11], s31 offen lds
    s_add_u32 s43, s43, 128
    s_add_u32 s51, s51, 1
    s_cmp_eq_u32 s51, 10
    s_cselect_b32 s31, 1280, 0
    s_cselect_b32 s51, 0, s51
    s_sub_u32 s43, s43, s31
    s_add_u32 s47, s47, 16384
    s_cmp_eq_u32 s47, 49152
    s_cselect_b32 s47, 0, s47
    s_add_u32 s57, s55, s48
    s_add_u32 s58, s56, s48
    s_add_u32 m0, s57, 0
    s_nop 0
    buffer_load_dwordx4 v5, s[12:15], s44 offen lds
    s_add_u32 m0, s57, 1024
    s_nop 0
    buffer_load_dwordx4 v6, s[12:15], s44 offen lds
    s_add_u32 m0, s57, 2048
    s_nop 0
    buffer_load_dwordx4 v7, s[12:15], s44 offen lds
    s_add_u32 m0, s58, 0
    s_add_u32 s31, s45, 0
    buffer_load_dwordx4 v8, s[16:19], s31 offen lds
    s_add_u32 m0, s58, 4096
    s_add_u32 s31, s45, 0
    buffer_load_dwordx4 v8, s[20:23], s31 offen lds
    s_add_u32 s44, s44, 122880
    s_add_u32 s45, s45, 98304
    s_add_u32 s52, s52, 1
    s_cmp_eq_u32 s52, 20
    s_cselect_b32 s31, 2457600, 0
    s_cselect_b32 s32, 1966080, 0
    s_cselect_b32 s52, 0, s52
    s_sub_u32 s44, s44, s31
    s_sub_u32 s45, s45, s32
    s_add_u32 s48, s48, 20480
    s_cmp_eq_u32 s48, 102400
    s_cselect_b32 s48, 0, s48
    s_sub_u32 s50, s50, 1
    s_cmp_lg_u32 s50, 0
    s_cbranch_scc1 L_k1_lpairt1
    s_waitcnt vmcnt(14)
    s_barrier
    s_add_u32 s57, s55, s48
    s_add_u32 s58, s56, s48
    s_add_u32 m0, s57, 0
    s_nop 0
    buffer_load_dwordx4 v5, s[12:15], s44 offen lds
    s_add_u32 m0, s57, 1024
    s_nop 0
    buffer_load_dwordx4 v6, s[12:15], s44 offen lds
    s_add_u32 m0, s57, 2048
    s_nop 0
    buffer_load_dwordx4 v7, s[12:15], s44 offen lds
    s_add_u32 m0, s58, 0
    s_add_u32 s31, s45, 0
    buffer_load_dwordx4 v8, s[16:19], s31 offen lds
    s_add_u32 m0, s58, 4096
    s_add_u32 s31, s45, 0
    buffer_load_dwordx4 v8, s[20:23], s31 offen lds
    s_add_u32 s44, s44, 122880
    s_add_u32 s45, s45, 98304
    s_add_u32 s52, s52, 1
    s_cmp_eq_u32 s52, 20
    s_cselect_b32 s31, 2457600, 0
    s_cselect_b32 s32, 1966080, 0
    s_cselect_b32 s52, 0, s52
    s_sub_u32 s44, s44, s31
    s_sub_u32 s45, s45, s32
    s_add_u32 s48, s48, 20480
    s_cmp_eq_u32 s48, 102400
    s_cselect_b32 s48, 0, s48
L_k1_lsum:
    v_mov_b32 v10, 0
    global_load_dword v16, v10, s[66:67] sc1
    s_waitcnt vmcnt(15)
    s_barrier
    s_waitcnt vmcnt(0)
    s_barrier
    s_mov_b32 s50, 0x10000
L_k1_gpoll:
    v_readfirstlane_b32 s31, v16
    s_sub_u32 s50, s50, 1
    s_cbranch_scc1 L_k1_gok
    s_cmp_ge_u32 s31, 256
    s_cbranch_scc1 L_k1_gok
    s_sleep 2
    global_load_dword v16, v10, s[66:67] sc1
    s_waitcnt vmcnt(0)
    s_branch L_k1_gpoll
L_k1_gok:
    v_lshlrev_b32 v11, 2, v2
    s_lshl_b32 s32, s42, 8
    v_add_u32 v11, s32, v11
    v_lshlrev_b32 v12, 2, v2
    v_add_u32 v12, 1024, v12
    v_mov_b32 v13, 0x7ff00000
    s_cmp_eq_u32 s42, 0
    s_cselect_b64 vcc, -1, 0
    s_mul_i32 s31, s30, 20480
    s_add_u32 s31, s31, 10485760
    v_cndmask_b32 v13, v13, v12, vcc
    buffer_load_dword v16, v11, s[24:27], s31 offen sc1
    buffer_load_dword v32, v13, s[24:27], s31 offen sc1
    s_add_u32 s31, s31, 1280
    buffer_load_dword v17, v11, s[24:27], s31 offen sc1
    buffer_load_dword v33, v13, s[24:27], s31 offen sc1
    s_add_u32 s31, s31, 1280
    buffer_load_dword v18, v11, s[24:27], s31 offen sc1
    buffer_load_dword v34, v13, s[24:27], s31 offen sc1
    s_add_u32 s31, s31, 1280
    buffer_load_dword v19, v11, s[24:27], s31 offen sc1
    buffer_load_dword v35, v13, s[24:27], s31 offen sc1
    s_add_u32 s31, s31, 1280
    buffer_load_dword v20, v11, s[24:27], s31 offen sc1
    buffer_load_dword v36, v13, s[24:27], s31 offen sc1
    s_add_u32 s31, s31, 1280
    buffer_load_dword v21, v11, s[24:27], s31 offen sc1
    buffer_load_dword v37, v13, s[24:27], s31 offen sc1
    s_add_u32 s31, s31, 1280
    buffer_load_dword v22, v11, s[24:27], s31 offen sc1
    buffer_load_dword v38, v13, s[24:27], s31 offen sc1
    s_add_u32 s31, s31, 1280
    buffer_load_dword v23, v11, s[24:27], s31 offen sc1
    buffer_load_dword v39, v13, s[24:27], s31 offen sc1
    s_add_u32 s31, s31, 1280
    buffer_load_dword v24, v11, s[24:27], s31 offen sc1
    buffer_load_dword v40, v13, s[24:27], s31 offen sc1
    s_add_u32 s31, s31, 1280
    buffer_load_dword v25, v11, s[24:27], s31 offen sc1
    buffer_load_dword v41, v13, s[24:27], s31 offen sc1
    v_lshlrev_b32 v14, 4, v2
    s_lshl_b32 s32, s29, 10
    s_add_u32 s32, s32, 11010048
    buffer_load_dwordx4 v[48:51], v14, s[24:27], s32 offen sc1
    s_barrier
    s_waitcnt vmcnt(0)
    v_add_f32 v16, v16, v21
    v_add_f32 v32, v32, v37
    v_add_f32 v17, v17, v22
    v_add_f32 v33, v33, v38
    v_add_f32 v18, v18, v23
    v_add_f32 v34, v34, v39
    v_add_f32 v19, v19, v24
    v_add_f32 v35, v35, v40
    v_add_f32 v20, v20, v25
    v_add_f32 v36, v36, v41
    v_add_f32 v16, v16, v17
    v_add_f32 v32, v32, v33
    v_add_f32 v18, v18, v19
    v_add_f32 v34, v34, v35
    v_add_f32 v16, v16, v18
    v_add_f32 v32, v32, v34
    v_add_f32 v16, v16, v20
    v_add_f32 v32, v32, v36
    v_add_u32 v11, 152576, v11
    ds_write_b32 v11, v16
    s_cmp_lg_u32 s42, 0
    s_cbranch_scc1 L_k1_g2
    v_add_u32 v12, 152576, v12
    ds_write_b32 v12, v32
    v_add_u32 v14, 151552, v14
    ds_write_b128 v14, v[48:51]
L_k1_g2:
    s_waitcnt lgkmcnt(0)
    s_barrier
    s_barrier
    s_load_dwordx2 s[4:5], s[0:1], 48
    s_load_dwordx2 s[6:7], s[0:1], 16
    s_or_b32 s31, s2, s42
    s_cmp_lg_u32 s31, 0
    s_cbranch_scc1 L_k1_noflag
    v_lshlrev_b32 v10, 8, v2
    v_mov_b32 v11, 0
    s_mov_b32 s31, 24117248
    buffer_store_dword v11, v10, s[24:27], s31 offen
L_k1_noflag:
    s_waitcnt lgkmcnt(0)
    s_mov_b32 s8, s4
    s_and_b32 s9, s5, 0xffff
    s_mov_b32 s10, 1966080
    s_mov_b32 s11, 0x00020000
    s_mov_b32 s12, s6
    s_and_b32 s13, s7, 0xffff
    s_mov_b32 s14, 819200
    s_mov_b32 s15, 0x00020000
    s_lshl_b32 s31, s2, 2
    s_add_u32 s31, s31, s42
    v_lshlrev_b32 v10, 4, v2
    s_lshl_b32 s32, s31, 11
    buffer_load_dwordx4 v[16:19], v10, s[8:11], s32 offen
    buffer_load_dwordx4 v[20:23], v10, s[8:11], s32 offen offset:1024
    s_lshl_b32 s32, s31, 10
    buffer_load_dwordx4 v[24:27], v10, s[12:15], s32 offen
L_k1_end:
    s_endpgm
.globl main_kernel
.p2align 8
.type main_kernel,@function
main_kernel:
    s_cmp_ge_u32 s2, 256
    s_cbranch_scc1 L_main_end
    s_load_dwordx2 s[28:29], s[0:1], 72
    s_load_dwordx2 s[4:5], s[0:1], 48
    s_load_dwordx2 s[6:7], s[0:1], 16
    s_load_dwordx2 s[30:31], s[0:1], 0
    s_load_dwordx2 s[26:27], s[0:1], 56
    v_lshrrev_b32 v1, 6, v0
    v_and_b32 v2, 63, v0
    v_readfirstlane_b32 s20, v1
    v_mov_b32 v3, 65088
    v_mov_b32 v4, 0
    v_mov_b32 v5, 0
    v_mov_b32 v6, 0
    v_mov_b32 v7, 0
    ds_write_b128 v3, v[4:7]
    s_waitcnt lgkmcnt(0)
    s_mov_b32 s8, s28
    s_and_b32 s9, s29, 0xffff
    s_mov_b32 s10, 27262976
    s_mov_b32 s11, 0x00020000
    s_barrier
    s_cmp_ge_u32 s20, 8
    s_cbranch_scc1 L_main_gemm
    s_and_b32 s23, s2, 7
    s_lshr_b32 s22, s2, 3
    s_lshr_b32 s21, s22, 3
    s_lshl_b32 s23, s23, 2
    s_add_u32 s21, s21, s23
    s_and_b32 s22, s22, 7
    v_and_b32 v3, 31, v2
    v_lshrrev_b32 v4, 5, v2
    v_lshlrev_b32 v14, 4, v2
    s_mov_b32 s59, 0
    s_lshr_b32 s51, s20, 2
    s_and_b32 s52, s20, 3
    s_add_u32 s40, s20, 0
    s_lshr_b32 s41, s40, 1
    s_and_b32 s40, s40, 1
    s_mul_i32 s56, s41, 2080
    s_lshl_b32 s42, s40, 10
    s_add_u32 s56, s56, s42
    s_add_u32 s56, s56, 0
    s_cmp_ge_u32 s41, 5
    s_cselect_b32 s40, 155, 0
    s_add_u32 s41, s41, s40
    s_mul_i32 s40, s21, 5
    s_add_u32 s41, s41, s40
    s_add_u32 s41, s41, 160
    s_lshl_b32 s53, s41, 14
    s_add_u32 s53, s53, s42
    s_add_u32 s53, s53, 0
    s_add_u32 s40, s20, 8
    s_lshr_b32 s41, s40, 1
    s_and_b32 s40, s40, 1
    s_mul_i32 s57, s41, 2080
    s_lshl_b32 s42, s40, 10
    s_add_u32 s57, s57, s42
    s_add_u32 s57, s57, 0
    s_cmp_ge_u32 s41, 5
    s_cselect_b32 s40, 155, 0
    s_add_u32 s41, s41, s40
    s_mul_i32 s40, s21, 5
    s_add_u32 s41, s41, s40
    s_add_u32 s41, s41, 160
    s_lshl_b32 s54, s41, 14
    s_add_u32 s54, s54, s42
    s_add_u32 s54, s54, 0
    s_add_u32 s40, s20, 16
    s_lshr_b32 s41, s40, 1
    s_and_b32 s40, s40, 1
    s_mul_i32 s58, s41, 2080
    s_lshl_b32 s42, s40, 10
    s_add_u32 s58, s58, s42
    s_add_u32 s58, s58, 0
    s_cmp_ge_u32 s41, 5
    s_cselect_b32 s40, 155, 0
    s_add_u32 s41, s41, s40
    s_mul_i32 s40, s21, 5
    s_add_u32 s41, s41, s40
    s_add_u32 s41, s41, 160
    s_lshl_b32 s55, s41, 14
    s_add_u32 s55, s55, s42
    s_add_u32 s55, s55, 0
    s_add_u32 m0, s56, 0
    s_nop 0
    buffer_load_dwordx4 v14, s[8:11], s53 offen lds
    s_add_u32 m0, s57, 0
    s_nop 0
    buffer_load_dwordx4 v14, s[8:11], s54 offen lds
    s_cmp_ge_u32 s20, 4
    s_cbranch_scc1 L_attn_dma1
    s_add_u32 m0, s58, 0
    s_nop 0
    buffer_load_dwordx4 v14, s[8:11], s55 offen lds
L_attn_dma1:
    s_add_u32 s53, s53, 2048
    s_add_u32 s54, s54, 2048
    s_add_u32 s55, s55, 2048
    s_lshl_b32 s50, s22, 3
    s_lshl_b32 s40, s52, 1
    s_add_u32 s50, s50, s40
    s_lshl_b32 s41, s50, 8
    s_mul_i32 s42, s21, 81920
    s_add_u32 s41, s41, s42
    s_add_u32 s41, s41, 0
    v_lshlrev_b32 v9, 3, v3
    v_lshl_add_u32 v8, v4, 15, v9
    s_add_u32 s42, s41, 16384
    s_add_u32 s40, s41, 65536
    buffer_load_dwordx2 v[16:17], v8, s[8:11], s41 offen offset:0
    buffer_load_dwordx2 v[18:19], v8, s[8:11], s42 offen offset:0
    buffer_load_dwordx2 v[20:21], v9, s[8:11], s40 offen offset:0
    buffer_load_dwordx2 v[24:25], v8, s[8:11], s41 offen offset:256
    buffer_load_dwordx2 v[26:27], v8, s[8:11], s42 offen offset:256
    buffer_load_dwordx2 v[28:29], v9, s[8:11], s40 offen offset:256
    s_add_u32 m0, s56, 20992
    s_nop 0
    buffer_load_dwordx4 v14, s[8:11], s53 offen lds
    s_add_u32 m0, s57, 20992
    s_nop 0
    buffer_load_dwordx4 v14, s[8:11], s54 offen lds
    s_cmp_ge_u32 s20, 4
    s_cbranch_scc1 L_attn_dma2
    s_add_u32 m0, s58, 20992
    s_nop 0
    buffer_load_dwordx4 v14, s[8:11], s55 offen lds
L_attn_dma2:
    s_add_u32 s53, s53, 2048
    s_add_u32 s54, s54, 2048
    s_add_u32 s55, s55, 2048
    v_mul_u32_u24 v8, 4160, v4
    v_add_u32 v8, v8, v9
    v_add_u32 v8, 0, v8
    v_add_u32 v9, 8320, v9
    v_bfe_u32 v144, v2, 2, 2
    v_lshl_add_u32 v144, v4, 2, v144
    v_lshlrev_b32 v144, 3, v144
    v_and_b32 v145, 3, v2
    v_bfe_u32 v146, v2, 4, 1
    v_lshl_add_u32 v146, v146, 2, v145
    v_mul_u32_u24 v10, 2080, v146
    v_add_u32 v10, 10400, v10
    v_cmp_gt_u32 vcc, 5, v146
    v_mov_b32 v145, 63040
    v_mov_b32 v12, 1
    v_cndmask_b32 v10, v145, v10, vcc
    v_cndmask_b32 v15, 0, v12, vcc
    v_add_u32 v10, v10, v144
    v_mov_b32 v11, 65088
    s_cmp_lg_u32 s20, 0
    s_cbranch_scc1 L_attn_noones
    v_mov_b32 v144, 0x3f80
    v_mov_b32 v145, 0
    v_mov_b32 v146, 0x3f80
    v_mov_b32 v147, 0
    v_add_u32 v148, 63040, v14
    ds_write_b128 v148, v[144:147]
    ds_write_b128 v148, v[144:147] offset:1024
    s_waitcnt lgkmcnt(0)
L_attn_noones:
    v_mov_b32 v38, 0x3f80
    v_mov_b32 v39, 0
    v_mov_b32 v46, 0x3f80
    v_mov_b32 v47, 0
    v_mov_b32 v112, 0
    v_mov_b32 v113, 0
    v_mov_b32 v114, 0
    v_mov_b32 v115, 0
    v_mov_b32 v116, 0
    v_mov_b32 v117, 0
    v_mov_b32 v118, 0
    v_mov_b32 v119, 0
    v_mov_b32 v120, 0
    v_mov_b32 v121, 0
    v_mov_b32 v122, 0
    v_mov_b32 v123, 0
    v_mov_b32 v124, 0
    v_mov_b32 v125, 0
    v_mov_b32 v126, 0
    v_mov_b32 v127, 0
    v_mov_b32 v128, 0
    v_mov_b32 v129, 0
    v_mov_b32 v130, 0
    v_mov_b32 v131, 0
    v_mov_b32 v132, 0
    v_mov_b32 v133, 0
    v_mov_b32 v134, 0
    v_mov_b32 v135, 0
    v_mov_b32 v136, 0
    v_mov_b32 v137, 0
    v_mov_b32 v138, 0
    v_mov_b32 v139, 0
    v_mov_b32 v140, 0
    v_mov_b32 v141, 0
    v_mov_b32 v142, 0
    v_mov_b32 v143, 0
    v_mov_b32 v72, 0
    v_mov_b32 v56, 0
    v_mov_b32 v73, 0
    v_mov_b32 v57, 0
    v_mov_b32 v74, 0
    v_mov_b32 v58, 0
    v_mov_b32 v75, 0
    v_mov_b32 v59, 0
    v_mov_b32 v76, 0
    v_mov_b32 v60, 0
    v_mov_b32 v77, 0
    v_mov_b32 v61, 0
    v_mov_b32 v78, 0
    v_mov_b32 v62, 0
    v_mov_b32 v79, 0
    v_mov_b32 v63, 0
    v_cmp_eq_u32 vcc, 0, v4
    s_waitcnt vmcnt(2)
    s_nop 0
    v_cndmask_b32 v20, 0, v20, vcc
    v_cndmask_b32 v21, 0, v21, vcc
    v_mov_b32 v22, 0
    v_mov_b32 v23, 0
    v_cndmask_b32 v28, 0, v28, vcc
    v_cndmask_b32 v29, 0, v29, vcc
    v_mov_b32 v30, 0
    v_mov_b32 v31, 0
    s_mov_b64 exec, 1
    ds_add_u32 v11, v12
    s_mov_b64 exec, -1
    s_mov_b32 s47, 8
    s_mov_b32 s78, 0x40000
L_wait_attn0:
    ds_read_b32 v13, v11
    s_waitcnt lgkmcnt(0)
    v_readfirstlane_b32 s40, v13
    s_sub_u32 s78, s78, 1
    s_cbranch_scc1 L_go_attn0
    s_cmp_ge_u32 s40, s47
    s_cbranch_scc1 L_go_attn0
    s_sleep 1
    s_branch L_wait_attn0
L_go_attn0:
    v_mov_b32 v5, v8
    v_mov_b32 v6, v9
    ds_read_b64 v[32:33], v5 offset:0
    ds_read_b64 v[34:35], v5 offset:2080
    ds_read_b64 v[36:37], v6 offset:0
    ds_read_b64 v[40:41], v5 offset:256
    ds_read_b64 v[42:43], v5 offset:2336
    ds_read_b64 v[44:45], v6 offset:256
    s_lshl_b32 s40, s51, 8
    v_add_u32 v8, s40, v8
    v_add_u32 v9, s40, v9
    v_add_u32 v10, s40, v10
    s_waitcnt lgkmcnt(0)
    v_mfma_f32_32x32x16_bf16 v[80:95], v[32:35], v[16:19], 0
    v_mfma_f32_32x32x16_bf16 v[80:95], v[36:39], v[20:23], v[80:95]
    v_mfma_f32_32x32x16_bf16 v[96:111], v[32:35], v[24:27], 0
    v_mfma_f32_32x32x16_bf16 v[96:111], v[36:39], v[28:31], v[96:111]
    s_nop 7
    s_nop 3
    v_max3_f32 v144, v80, v81, v82
    v_max3_f32 v145, v83, v84, v85
    v_max3_f32 v144, v144, v86, v87
    v_max_f32 v145, v145, v88
    v_max3_f32 v145, v145, v89, v90
    v_max_f32 v144, v144, v91
    v_max3_f32 v144, v144, v92, v93
    v_max_f32 v145, v145, v94
    v_max_f32 v144, v144, v95
    v_max3_f32 v148, v96, v97, v98
    v_max3_f32 v149, v99, v100, v101
    v_max3_f32 v148, v148, v102, v103
    v_max_f32 v149, v149, v104
    v_max3_f32 v149, v149, v105, v106
    v_max_f32 v148, v148, v107
    v_max3_f32 v148, v148, v108, v109
    v_max_f32 v149, v149, v110
    v_max_f32 v148, v148, v111
    v_mfma_f32_32x32x16_bf16 v[80:95], v[40:43], v[16:19], 0
    v_mfma_f32_32x32x16_bf16 v[80:95], v[44:47], v[20:23], v[80:95]
    v_mfma_f32_32x32x16_bf16 v[96:111], v[40:43], v[24:27], 0
    v_mfma_f32_32x32x16_bf16 v[96:111], v[44:47], v[28:31], v[96:111]
    v_mov_b32 v5, v8
    v_mov_b32 v6, v9
    v_mov_b32 v7, v10
    ds_read_b64 v[32:33], v5 offset:0
    ds_read_b64 v[34:35], v5 offset:2080
    ds_read_b64 v[36:37], v6 offset:0
    s_nop 7
    v_cmp_eq_u32 vcc, 0, v4
    v_max3_f32 v144, v144, v80, v81
    v_max3_f32 v145, v145, v82, v83
    v_max3_f32 v144, v144, v84, v85
    v_max3_f32 v145, v145, v86, v87
    v_max3_f32 v144, v144, v88, v89
    v_max3_f32 v145, v145, v90, v91
    v_max3_f32 v144, v144, v92, v93
    v_max3_f32 v145, v145, v94, v95
    v_max3_f32 v148, v148, v96, v97
    v_max3_f32 v149, v149, v98, v99
    v_max3_f32 v148, v148, v100, v101
    v_max3_f32 v149, v149, v102, v103
    v_max3_f32 v148, v148, v104, v105
    v_max3_f32 v149, v149, v106, v107
    v_max3_f32 v148, v148, v108, v109
    v_max3_f32 v149, v149, v110, v111
    v_max_f32 v144, v144, v145
    v_mov_b32 v145, v144
    v_max_f32 v148, v148, v149
    v_mov_b32 v149, v148
    s_nop 0
    v_permlane32_swap_b32 v144, v145
    v_permlane32_swap_b32 v148, v149
    s_nop 0
    v_max_f32 v144, v144, v145
    v_add_f32 v144, 0x42d00000, v144
    v_sub_f32 v144, 0, v144
    v_cvt_pk_bf16_f32 v144, v144, 0
    v_cndmask_b32 v22, 0, v144, vcc
    v_max_f32 v148, v148, v149
    v_add_f32 v148, 0x42d00000, v148
    v_sub_f32 v148, 0, v148
    v_cvt_pk_bf16_f32 v148, v148, 0
    v_cndmask_b32 v30, 0, v148, vcc
    s_waitcnt lgkmcnt(0)
    s_nop 0
    v_mfma_f32_32x32x16_bf16 v[80:95], v[32:35], v[16:19], 0
    v_mfma_f32_32x32x16_bf16 v[80:95], v[36:39], v[20:23], v[80:95]
    s_mov_b32 s46, 0
    s_mov_b32 s48, 0
    s_mov_b32 s47, 8
    s_nop 7
.p2align 3
L_attn_chunk:
    s_waitcnt vmcnt(0)
    s_mov_b64 exec, 1
    ds_add_u32 v11, v12
    s_mov_b64 exec, -1
    s_add_u32 s47, s47, 8
    s_add_u32 s49, s48, 20992
    s_cmp_eq_u32 s49, 62976
    s_cselect_b32 s49, 0, s49
    s_setprio 2
    v_mfma_f32_32x32x16_bf16 v[96:111], v[32:35], v[24:27], 0
    v_exp_f32 v80, v80
    v_exp_f32 v81, v81
    v_exp_f32 v82, v82
    v_cvt_pk_bf16_f32 v64, v80, v81
    v_exp_f32 v83, v83
    v_exp_f32 v84, v84
    v_mfma_f32_32x32x16_bf16 v[96:111], v[36:39], v[28:31], v[96:111]
    ds_read_b64 v[40:41], v5 offset:512
    ds_read_b64 v[42:43], v5 offset:2592
    ds_read_b64 v[44:45], v6 offset:512
    v_cvt_pk_bf16_f32 v65, v82, v83
    v_exp_f32 v85, v85
    v_exp_f32 v86, v86
    v_cvt_pk_bf16_f32 v66, v84, v85
    v_exp_f32 v87, v87
    v_exp_f32 v88, v88
    v_mfma_f32_32x32x16_bf16 v[128:143], v[56:59], v[72:75], v[128:143]
    v_cvt_pk_bf16_f32 v67, v86, v87
    v_exp_f32 v89, v89
    v_exp_f32 v90, v90
    v_cvt_pk_bf16_f32 v68, v88, v89
    v_exp_f32 v91, v91
    v_exp_f32 v92, v92
    v_mfma_f32_32x32x16_bf16 v[128:143], v[60:63], v[76:79], v[128:143]
    ds_read_b64_tr_b16 v[48:49], v7 offset:0
    ds_read_b64_tr_b16 v[50:51], v7 offset:64
    ds_read_b64_tr_b16 v[52:53], v7 offset:128
    ds_read_b64_tr_b16 v[54:55], v7 offset:192
    v_cvt_pk_bf16_f32 v69, v90, v91
    v_exp_f32 v93, v93
    v_exp_f32 v94, v94
    v_exp_f32 v95, v95
    v_cvt_pk_bf16_f32 v70, v92, v93
    v_cvt_pk_bf16_f32 v71, v94, v95
    s_setprio 1
    s_waitcnt lgkmcnt(4)
    v_mfma_f32_32x32x16_bf16 v[80:95], v[40:43], v[16:19], 0
    v_exp_f32 v96, v96
    v_exp_f32 v97, v97
    v_exp_f32 v98, v98
    v_cvt_pk_bf16_f32 v72, v96, v97
    v_exp_f32 v99, v99
    v_exp_f32 v100, v100
    v_mfma_f32_32x32x16_bf16 v[80:95], v[44:47], v[20:23], v[80:95]
    v_cvt_pk_bf16_f32 v73, v98, v99
    v_exp_f32 v101, v101
    v_exp_f32 v102, v102
    v_cvt_pk_bf16_f32 v74, v100, v101
    v_exp_f32 v103, v103
    v_exp_f32 v104, v104
    s_waitcnt lgkmcnt(0)
    v_mfma_f32_32x32x16_bf16 v[112:127], v[48:51], v[64:67], v[112:127]
    v_cvt_pk_bf16_f32 v75, v102, v103
    v_exp_f32 v105, v105
    v_exp_f32 v106, v106
    v_cvt_pk_bf16_f32 v76, v104, v105
    v_exp_f32 v107, v107
    v_exp_f32 v108, v108
    v_mfma_f32_32x32x16_bf16 v[112:127], v[52:55], v[68:71], v[112:127]
    v_cvt_pk_bf16_f32 v77, v106, v107
    v_exp_f32 v109, v109
    v_exp_f32 v110, v110
    v_exp_f32 v111, v111
    v_cvt_pk_bf16_f32 v78, v108, v109
    v_cvt_pk_bf16_f32 v79, v110, v111
    s_setprio 0
    v_mfma_f32_32x32x16_bf16 v[96:111], v[40:43], v[24:27], 0
    v_exp_f32 v80, v80
    v_exp_f32 v81, v81
    v_exp_f32 v82, v82
    v_cvt_pk_bf16_f32 v64, v80, v81
    v_exp_f32 v83, v83
    v_exp_f32 v84, v84
    v_mfma_f32_32x32x16_bf16 v[96:111], v[44:47], v[28:31], v[96:111]
    ds_read_b64 v[32:33], v5 offset:1024
    ds_read_b64 v[34:35], v5 offset:3104
    ds_read_b64 v[36:37], v6 offset:1024
    v_cvt_pk_bf16_f32 v65, v82, v83
    v_exp_f32 v85, v85
    v_exp_f32 v86, v86
    v_cvt_pk_bf16_f32 v66, v84, v85
    v_exp_f32 v87, v87
    v_exp_f32 v88, v88
    v_mfma_f32_32x32x16_bf16 v[128:143], v[48:51], v[72:75], v[128:143]
    v_cvt_pk_bf16_f32 v67, v86, v87
    v_exp_f32 v89, v89
    v_exp_f32 v90, v90
    v_cvt_pk_bf16_f32 v68, v88, v89
    v_exp_f32 v91, v91
    v_exp_f32 v92, v92
    v_mfma_f32_32x32x16_bf16 v[128:143], v[52:55], v[76:79], v[128:143]
    ds_read_b64_tr_b16 v[56:57], v7 offset:512
    ds_read_b64_tr_b16 v[58:59], v7 offset:576
    ds_read_b64_tr_b16 v[60:61], v7 offset:640
    ds_read_b64_tr_b16 v[62:63], v7 offset:704
    v_cvt_pk_bf16_f32 v69, v90, v91
    v_exp_f32 v93, v93
    v_exp_f32 v94, v94
    v_exp_f32 v95, v95
    v_cvt_pk_bf16_f32 v70, v92, v93
    v_cvt_pk_bf16_f32 v71, v94, v95
    s_setprio 2
    s_waitcnt lgkmcnt(4)
    v_mfma_f32_32x32x16_bf16 v[80:95], v[32:35], v[16:19], 0
    v_exp_f32 v96, v96
    v_exp_f32 v97, v97
    v_exp_f32 v98, v98
    v_cvt_pk_bf16_f32 v72, v96, v97
    v_exp_f32 v99, v99
    v_exp_f32 v100, v100
    v_mfma_f32_32x32x16_bf16 v[80:95], v[36:39], v[20:23], v[80:95]
    v_cvt_pk_bf16_f32 v73, v98, v99
    v_exp_f32 v101, v101
    v_exp_f32 v102, v102
    v_cvt_pk_bf16_f32 v74, v100, v101
    v_exp_f32 v103, v103
    v_exp_f32 v104, v104
    s_waitcnt lgkmcnt(0)
    v_mfma_f32_32x32x16_bf16 v[112:127], v[56:59], v[64:67], v[112:127]
    v_cvt_pk_bf16_f32 v75, v102, v103
    v_exp_f32 v105, v105
    v_exp_f32 v106, v106
    v_cvt_pk_bf16_f32 v76, v104, v105
    v_exp_f32 v107, v107
    v_exp_f32 v108, v108
    v_mfma_f32_32x32x16_bf16 v[112:127], v[60:63], v[68:71], v[112:127]
    v_cvt_pk_bf16_f32 v77, v106, v107
    v_exp_f32 v109, v109
    v_exp_f32 v110, v110
    v_exp_f32 v111, v111
    v_cvt_pk_bf16_f32 v78, v108, v109
    v_cvt_pk_bf16_f32 v79, v110, v111
    s_mov_b32 s78, 0x40000
L_wait_attn:
    ds_read_b32 v13, v11
    s_waitcnt lgkmcnt(0)
    v_readfirstlane_b32 s40, v13
    s_sub_u32 s78, s78, 1
    s_cbranch_scc1 L_go_attn
    s_cmp_ge_u32 s40, s47
    s_cbranch_scc1 L_go_attn
    s_sleep 1
    s_branch L_wait_attn
L_go_attn:
    s_cmp_ge_u32 s46, 6
    s_cbranch_scc1 L_attn_nodma
    s_add_u32 s41, s49, 20992
    s_cmp_eq_u32 s41, 62976
    s_cselect_b32 s41, 0, s41
    s_add_u32 m0, s56, s41
    s_nop 0
    buffer_load_dwordx4 v14, s[8:11], s53 offen lds
    s_add_u32 m0, s57, s41
    s_nop 0
    buffer_load_dwordx4 v14, s[8:11], s54 offen lds
    s_cmp_ge_u32 s20, 4
    s_cbranch_scc1 L_attn_dma3
    s_add_u32 m0, s58, s41
    s_nop 0
    buffer_load_dwordx4 v14, s[8:11], s55 offen lds
L_attn_dma3:
    s_add_u32 s53, s53, 2048
    s_add_u32 s54, s54, 2048
    s_add_u32 s55, s55, 2048
L_attn_nodma:
    s_setprio 1
    v_mfma_f32_32x32x16_bf16 v[96:111], v[32:35], v[24:27], 0
    v_exp_f32 v80, v80
    v_exp_f32 v81, v81
    v_exp_f32 v82, v82
    v_cvt_pk_bf16_f32 v64, v80, v81
    v_exp_f32 v83, v83
    v_exp_f32 v84, v84
    v_mfma_f32_32x32x16_bf16 v[96:111], v[36:39], v[28:31], v[96:111]
    ds_read_b64 v[40:41], v5 offset:1536
    ds_read_b64 v[42:43], v5 offset:3616
    ds_read_b64 v[44:45], v6 offset:1536
    v_cvt_pk_bf16_f32 v65, v82, v83
    v_exp_f32 v85, v85
    v_exp_f32 v86, v86
    v_cvt_pk_bf16_f32 v66, v84, v85
    v_exp_f32 v87, v87
    v_exp_f32 v88, v88
    v_mfma_f32_32x32x16_bf16 v[128:143], v[56:59], v[72:75], v[128:143]
    v_cvt_pk_bf16_f32 v67, v86, v87
    v_exp_f32 v89, v89
    v_exp_f32 v90, v90
    v_cvt_pk_bf16_f32 v68, v88, v89
    v_exp_f32 v91, v91
    v_exp_f32 v92, v92
    v_mfma_f32_32x32x16_bf16 v[128:143], v[60:63], v[76:79], v[128:143]
    ds_read_b64_tr_b16 v[48:49], v7 offset:1024
    ds_read_b64_tr_b16 v[50:51], v7 offset:1088
    ds_read_b64_tr_b16 v[52:53], v7 offset:1152
    ds_read_b64_tr_b16 v[54:55], v7 offset:1216
    v_cvt_pk_bf16_f32 v69, v90, v91
    v_exp_f32 v93, v93
    v_exp_f32 v94, v94
    v_exp_f32 v95, v95
    v_cvt_pk_bf16_f32 v70, v92, v93
    v_cvt_pk_bf16_f32 v71, v94, v95
    s_setprio 0
    s_waitcnt lgkmcnt(4)
    v_mfma_f32_32x32x16_bf16 v[80:95], v[40:43], v[16:19], 0
    v_exp_f32 v96, v96
    v_exp_f32 v97, v97
    v_exp_f32 v98, v98
    v_cvt_pk_bf16_f32 v72, v96, v97
    v_exp_f32 v99, v99
    v_exp_f32 v100, v100
    v_mfma_f32_32x32x16_bf16 v[80:95], v[44:47], v[20:23], v[80:95]
    v_cvt_pk_bf16_f32 v73, v98, v99
    v_exp_f32 v101, v101
    v_exp_f32 v102, v102
    v_cvt_pk_bf16_f32 v74, v100, v101
    v_exp_f32 v103, v103
    v_exp_f32 v104, v104
    s_waitcnt lgkmcnt(0)
    v_mfma_f32_32x32x16_bf16 v[112:127], v[48:51], v[64:67], v[112:127]
    v_cvt_pk_bf16_f32 v75, v102, v103
    v_exp_f32 v105, v105
    v_exp_f32 v106, v106
    v_cvt_pk_bf16_f32 v76, v104, v105
    v_exp_f32 v107, v107
    v_exp_f32 v108, v108
    v_mfma_f32_32x32x16_bf16 v[112:127], v[52:55], v[68:71], v[112:127]
    v_cvt_pk_bf16_f32 v77, v106, v107
    v_exp_f32 v109, v109
    v_exp_f32 v110, v110
    v_exp_f32 v111, v111
    v_cvt_pk_bf16_f32 v78, v108, v109
    v_cvt_pk_bf16_f32 v79, v110, v111
    s_setprio 2
    v_mfma_f32_32x32x16_bf16 v[96:111], v[40:43], v[24:27], 0
    v_add_u32 v5, s49, v8
    v_add_u32 v6, s49, v9
    v_exp_f32 v80, v80
    v_exp_f32 v81, v81
    v_exp_f32 v82, v82
    v_cvt_pk_bf16_f32 v64, v80, v81
    v_exp_f32 v83, v83
    v_exp_f32 v84, v84
    v_mfma_f32_32x32x16_bf16 v[96:111], v[44:47], v[28:31], v[96:111]
    ds_read_b64 v[32:33], v5 offset:0
    ds_read_b64 v[34:35], v5 offset:2080
    ds_read_b64 v[36:37], v6 offset:0
    v_cvt_pk_bf16_f32 v65, v82, v83
    v_exp_f32 v85, v85
    v_exp_f32 v86, v86
    v_cvt_pk_bf16_f32 v66, v84, v85
    v_exp_f32 v87, v87
    v_exp_f32 v88, v88
    v_mfma_f32_32x32x16_bf16 v[128:143], v[48:51], v[72:75], v[128:143]
    v_cvt_pk_bf16_f32 v67, v86, v87
    v_exp_f32 v89, v89
    v_exp_f32 v90, v90
    v_cvt_pk_bf16_f32 v68, v88, v89
    v_exp_f32 v91, v91
    v_exp_f32 v92, v92
    v_mfma_f32_32x32x16_bf16 v[128:143], v[52:55], v[76:79], v[128:143]
    ds_read_b64_tr_b16 v[56:57], v7 offset:1536
    ds_read_b64_tr_b16 v[58:59], v7 offset:1600
    ds_read_b64_tr_b16 v[60:61], v7 offset:1664
    ds_read_b64_tr_b16 v[62:63], v7 offset:1728
    v_cvt_pk_bf16_f32 v69, v90, v91
    v_exp_f32 v93, v93
    v_exp_f32 v94, v94
    v_exp_f32 v95, v95
    v_cvt_pk_bf16_f32 v70, v92, v93
    v_cvt_pk_bf16_f32 v71, v94, v95
    s_setprio 0
    s_waitcnt lgkmcnt(4)
    v_mfma_f32_32x32x16_bf16 v[80:95], v[32:35], v[16:19], 0
    v_exp_f32 v96, v96
    v_exp_f32 v97, v97
    v_exp_f32 v98, v98
    v_cvt_pk_bf16_f32 v72, v96, v97
    v_exp_f32 v99, v99
    v_exp_f32 v100, v100
    v_mfma_f32_32x32x16_bf16 v[80:95], v[36:39], v[20:23], v[80:95]
    v_cvt_pk_bf16_f32 v73, v98, v99
    v_exp_f32 v101, v101
    v_exp_f32 v102, v102
    v_cvt_pk_bf16_f32 v74, v100, v101
    v_exp_f32 v103, v103
    v_exp_f32 v104, v104
    s_waitcnt lgkmcnt(0)
    v_mfma_f32_32x32x16_bf16 v[112:127], v[56:59], v[64:67], v[112:127]
    v_cvt_pk_bf16_f32 v75, v102, v103
    v_exp_f32 v105, v105
    v_exp_f32 v106, v106
    v_cvt_pk_bf16_f32 v76, v104, v105
    v_exp_f32 v107, v107
    v_exp_f32 v108, v108
    v_mfma_f32_32x32x16_bf16 v[112:127], v[60:63], v[68:71], v[112:127]
    v_cvt_pk_bf16_f32 v77, v106, v107
    v_exp_f32 v109, v109
    v_exp_f32 v110, v110
    v_exp_f32 v111, v111
    v_cvt_pk_bf16_f32 v78, v108, v109
    v_cvt_pk_bf16_f32 v79, v110, v111
    v_mad_u32_u24 v7, s49, v15, v10
    s_mov_b32 s48, s49
    s_add_u32 s46, s46, 1
    s_cmp_lt_u32 s46, 8
    s_cbranch_scc1 L_attn_chunk
    v_mfma_f32_32x32x16_bf16 v[128:143], v[56:59], v[72:75], v[128:143]
    v_mfma_f32_32x32x16_bf16 v[128:143], v[60:63], v[76:79], v[128:143]
    s_mul_i32 s40, s51, 41984
    s_mul_i32 s42, s52, 3072
    s_add_u32 s42, s42, 0
    s_add_u32 s40, s40, s42
    v_add_u32 v144, s40, v14
    s_xor_b32 s41, s51, 1
    s_mul_i32 s41, s41, 41984
    s_add_u32 s41, s41, s42
    v_add_u32 v145, s41, v14
    s_cmp_eq_u32 s51, 0
    s_nop 4
    s_cbranch_scc1 L_attn_give_b
    ds_write_b128 v144, v[112:115] offset:0
    ds_write_b128 v144, v[116:119] offset:1024
    ds_write_b128 v144, v[120:123] offset:2048
    v_mov_b32 v112, v128
    v_mov_b32 v113, v129
    v_mov_b32 v114, v130
    v_mov_b32 v115, v131
    v_mov_b32 v116, v132
    v_mov_b32 v117, v133
    v_mov_b32 v118, v134
    v_mov_b32 v119, v135
    v_mov_b32 v120, v136
    v_mov_b32 v121, v137
    v_mov_b32 v122, v138
    v_mov_b32 v123, v139
    v_mov_b32 v16, v24
    v_mov_b32 v17, v25
    v_mov_b32 v18, v26
    v_mov_b32 v19, v27
    v_mov_b32 v20, v28
    v_mov_b32 v21, v29
    s_add_u32 s50, s50, 1
    s_branch L_attn_given
L_attn_give_b:
    ds_write_b128 v144, v[128:131] offset:0
    ds_write_b128 v144, v[132:135] offset:1024
    ds_write_b128 v144, v[136:139] offset:2048
L_attn_given:
    s_waitcnt lgkmcnt(0)
    s_mov_b64 exec, 1
    ds_add_u32 v11, v12
    s_mov_b64 exec, -1
    s_add_u32 s47, s47, 8
    s_mov_b32 s78, 0x40000
L_wait_attnx:
    ds_read_b32 v13, v11
    s_waitcnt lgkmcnt(0)
    v_readfirstlane_b32 s40, v13
    s_sub_u32 s78, s78, 1
    s_cbranch_scc1 L_go_attnx
    s_cmp_ge_u32 s40, s47
    s_cbranch_scc1 L_go_attnx
    s_sleep 1
    s_branch L_wait_attnx
L_go_attnx:
    ds_read_b128 v[80:83], v145 offset:0
    ds_read_b128 v[84:87], v145 offset:1024
    ds_read_b128 v[88:91], v145 offset:2048
    s_waitcnt lgkmcnt(0)
    v_add_f32 v112, v112, v80
    v_add_f32 v113, v113, v81
    v_add_f32 v114, v114, v82
    v_add_f32 v115, v115, v83
    v_add_f32 v116, v116, v84
    v_add_f32 v117, v117, v85
    v_add_f32 v118, v118, v86
    v_add_f32 v119, v119, v87
    v_add_f32 v120, v120, v88
    v_add_f32 v121, v121, v89
    v_add_f32 v122, v122, v90
    v_add_f32 v123, v123, v91
L_attn_check:
    v_mov_b32 v144, v120
    v_mov_b32 v145, v120
    v_mul_f32 v146, 0, v112
    s_nop 0
    v_permlane32_swap_b32 v144, v145
    v_fma_f32 v146, v113, 0, v146
    v_fma_f32 v146, v114, 0, v146
    v_fma_f32 v146, v115, 0, v146
    v_fma_f32 v146, v116, 0, v146
    v_fma_f32 v146, v117, 0, v146
    v_fma_f32 v146, v118, 0, v146
    v_fma_f32 v146, v119, 0, v146
    v_fma_f32 v146, v120, 0, v146
    v_fma_f32 v146, v121, 0, v146
    v_fma_f32 v146, v122, 0, v146
    v_fma_f32 v146, v123, 0, v146
    s_cmp_eq_u32 s59, 1
    s_cbranch_scc1 L_attn_norm
    v_mov_b32 v147, 0xa000000
    v_mov_b32 v148, 0x7d800000
    v_cmp_ge_f32 vcc, v145, v147
    v_cmp_le_f32 s[60:61], v145, v148
    v_cmp_o_f32 s[62:63], v146, v146
    s_nop 0
    s_and_b64 vcc, vcc, s[60:61]
    s_and_b64 vcc, vcc, s[62:63]
    s_cmp_eq_u64 vcc, exec
    s_cbranch_scc0 L_attn_exact
L_attn_norm:
    v_rcp_f32 v144, v145
    s_nop 0
    v_mul_f32 v112, v112, v144
    v_mul_f32 v113, v113, v144
    v_mul_f32 v114, v114, v144
    v_mul_f32 v115, v115, v144
    v_mul_f32 v116, v116, v144
    v_mul_f32 v117, v117, v144
    v_mul_f32 v118, v118, v144
    v_mul_f32 v119, v119, v144
    v_mul_f32 v120, v120, v144
    v_mul_f32 v121, v121, v144
    v_mul_f32 v122, v122, v144
    v_mul_f32 v123, v123, v144
    v_cvt_pk_bf16_f32 v64, v112, v113
    v_cvt_pk_bf16_f32 v65, v114, v115
    v_cvt_pk_bf16_f32 v66, v116, v117
    v_cvt_pk_bf16_f32 v67, v118, v119
    v_cvt_pk_bf16_f32 v68, v120, v121
    v_cvt_pk_bf16_f32 v69, v122, v123
    s_lshl_b32 s41, s50, 5
    s_add_u32 s41, s41, s21
    s_lshl_b32 s40, s41, 10
    s_add_u32 s40, s40, 20971520
    buffer_store_dwordx4 v[64:67], v14, s[8:11], s40 offen sc1
    s_lshl_b32 s40, s41, 8
    s_add_u32 s40, s40, 23068672
    v_lshlrev_b32 v144, 3, v3
    s_mov_b32 exec_hi, 0
    buffer_store_dwordx2 v[68:69], v144, s[8:11], s40 offen sc1
    s_mov_b64 exec, -1
    s_waitcnt vmcnt(0)
    v_mov_b32 v3, 65092
    v_mov_b32 v4, 1
    s_mov_b64 exec, 1
    ds_add_rtn_u32 v5, v3, v4
    s_waitcnt lgkmcnt(0)
    v_readfirstlane_b32 s23, v5
    s_lshl_b32 s24, s22, 8
    s_add_u32 s24, s24, 24117248
    s_cmp_lg_u32 s23, 7
    s_cbranch_scc1 L_main_nosig
    v_mov_b32 v3, 0
    buffer_atomic_add v4, v3, s[8:11], s24 offen
L_main_nosig:
    s_mov_b64 exec, -1
    s_endpgm
L_attn_exact:
    s_mov_b32 s59, 1
    s_mul_i32 s43, s21, 81920
    s_add_u32 s43, s43, 2621440
    s_add_u32 s44, s43, 2621440
    v_lshlrev_b32 v6, 3, v3
    v_lshl_add_u32 v5, v4, 15, v6
    v_mov_b32 v22, 0
    v_mov_b32 v23, 0
    v_mov_b32 v38, 0x3f803f80
    v_mov_b32 v39, 0x3f80
    v_mov_b32 v10, 0xff800000
    s_mov_b32 s45, s43
    s_mov_b32 s46, 64
L_attn_max:
    s_add_u32 s40, s45, 16384
    s_add_u32 s41, s45, 65536
    buffer_load_dwordx2 v[32:33], v5, s[8:11], s45 offen
    buffer_load_dwordx2 v[34:35], v5, s[8:11], s40 offen
    buffer_load_dwordx2 v[36:37], v6, s[8:11], s41 offen
    s_waitcnt vmcnt(0)
    v_mfma_f32_32x32x16_bf16 v[80:95], v[32:35], v[16:19], 0
    v_mfma_f32_32x32x16_bf16 v[80:95], v[36:39], v[20:23], v[80:95]
    s_nop 7
    s_nop 3
    v_max3_f32 v10, v10, v80, v81
    v_max3_f32 v10, v10, v82, v83
    v_max3_f32 v10, v10, v84, v85
    v_max3_f32 v10, v10, v86, v87
    v_max3_f32 v10, v10, v88, v89
    v_max3_f32 v10, v10, v90, v91
    v_max3_f32 v10, v10, v92, v93
    v_max3_f32 v10, v10, v94, v95
    s_add_u32 s45, s45, 256
    s_sub_u32 s46, s46, 1
    s_cmp_lg_u32 s46, 0
    s_cbranch_scc1 L_attn_max
    v_mov_b32 v144, v10
    s_nop 1
    v_permlane32_swap_b32 v10, v144
    s_nop 0
    v_max_f32 v10, v10, v144
    v_sub_f32 v10, 0, v10
    v_and_b32 v144, 0xffff0000, v10
    v_sub_f32 v145, v10, v144
    v_and_b32 v146, 0xffff0000, v145
    v_sub_f32 v147, v145, v146
    v_lshrrev_b32 v144, 16, v144
    v_or_b32 v144, v144, v146
    v_lshrrev_b32 v147, 16, v147
    v_cmp_eq_u32 vcc, 0, v4
    s_mul_i32 s40, s20, 2624
    s_add_u32 s42, s40, 20992
    v_cndmask_b32 v22, 0, v144, vcc
    v_cndmask_b32 v23, 0, v147, vcc
    v_mul_u32_u24 v7, 49152, v4
    v_add_u32 v7, v7, v6
    v_mul_u32_u24 v8, 864, v4
    v_add_u32 v8, v8, v6
    v_add_u32 v8, s42, v8
    v_bfe_u32 v144, v2, 2, 2
    v_lshl_add_u32 v144, v4, 2, v144
    v_lshlrev_b32 v144, 3, v144
    v_and_b32 v145, 3, v2
    v_bfe_u32 v146, v2, 4, 1
    v_lshl_add_u32 v146, v146, 2, v145
    v_mul_u32_u24 v9, 288, v146
    v_add_u32 v9, s42, v9
    v_cmp_gt_u32 vcc, 5, v146
    v_mov_b32 v145, 63040
    s_nop 0
    v_cndmask_b32 v9, v145, v9, vcc
    v_add_u32 v9, v9, v144
    v_mov_b32 v112, 0
    v_mov_b32 v113, 0
    v_mov_b32 v114, 0
    v_mov_b32 v115, 0
    v_mov_b32 v116, 0
    v_mov_b32 v117, 0
    v_mov_b32 v118, 0
    v_mov_b32 v119, 0
    v_mov_b32 v120, 0
    v_mov_b32 v121, 0
    v_mov_b32 v122, 0
    v_mov_b32 v123, 0
    v_mov_b32 v124, 0
    v_mov_b32 v125, 0
    v_mov_b32 v126, 0
    v_mov_b32 v127, 0
    s_mov_b32 s45, s43
    s_mov_b32 s48, s44
    s_mov_b32 s46, 64
L_attn_again:
    s_add_u32 s40, s45, 16384
    s_add_u32 s41, s45, 65536
    buffer_load_dwordx2 v[32:33], v5, s[8:11], s45 offen
    buffer_load_dwordx2 v[34:35], v5, s[8:11], s40 offen
    buffer_load_dwordx2 v[36:37], v6, s[8:11], s41 offen
    s_add_u32 s40, s48, 0
    buffer_load_dwordx2 v[72:73], v7, s[8:11], s40 offen
    s_add_u32 s40, s48, 16384
    buffer_load_dwordx2 v[74:75], v7, s[8:11], s40 offen
    s_add_u32 s40, s48, 32768
    buffer_load_dwordx2 v[76:77], v7, s[8:11], s40 offen
    s_waitcnt vmcnt(0)
    v_mfma_f32_32x32x16_bf16 v[80:95], v[32:35], v[16:19], 0
    v_mfma_f32_32x32x16_bf16 v[80:95], v[36:39], v[20:23], v[80:95]
    ds_write_b64 v8, v[72:73]
    ds_write_b64 v8, v[74:75] offset:288
    s_mov_b32 exec_hi, 0
    ds_write_b64 v8, v[76:77] offset:576
    s_mov_b64 exec, -1
    s_waitcnt lgkmcnt(0)
    ds_read_b64_tr_b16 v[48:49], v9 offset:0
    ds_read_b64_tr_b16 v[50:51], v9 offset:64
    ds_read_b64_tr_b16 v[52:53], v9 offset:128
    ds_read_b64_tr_b16 v[54:55], v9 offset:192
    s_nop 7
    v_exp_f32 v80, v80
    v_exp_f32 v81, v81
    v_exp_f32 v82, v82
    v_exp_f32 v83, v83
    v_exp_f32 v84, v84
    v_exp_f32 v85, v85
    v_exp_f32 v86, v86
    v_exp_f32 v87, v87
    v_exp_f32 v88, v88
    v_exp_f32 v89, v89
    v_exp_f32 v90, v90
    v_exp_f32 v91, v91
    v_exp_f32 v92, v92
    v_exp_f32 v93, v93
    v_exp_f32 v94, v94
    v_exp_f32 v95, v95
    s_nop 0
    v_cvt_pk_bf16_f32 v64, v80, v81
    v_cvt_pk_bf16_f32 v65, v82, v83
    v_cvt_pk_bf16_f32 v66, v84, v85
    v_cvt_pk_bf16_f32 v67, v86, v87
    v_cvt_pk_bf16_f32 v68, v88, v89
    v_cvt_pk_bf16_f32 v69, v90, v91
    v_cvt_pk_bf16_f32 v70, v92, v93
    v_cvt_pk_bf16_f32 v71, v94, v95
    s_waitcnt lgkmcnt(0)
    s_nop 0
    v_mfma_f32_32x32x16_bf16 v[112:127], v[48:51], v[64:67], v[112:127]
    v_mfma_f32_32x32x16_bf16 v[112:127], v[52:55], v[68:71], v[112:127]
    s_add_u32 s45, s45, 256
    s_add_u32 s48, s48, 256
    s_sub_u32 s46, s46, 1
    s_cmp_lg_u32 s46, 0
    s_cbranch_scc1 L_attn_again
    s_nop 7
    s_nop 7
    s_branch L_attn_check
L_main_gemm:
    s_mov_b32 s12, s4
    s_and_b32 s13, s5, 0xffff
    s_mov_b32 s14, 1966080
    s_mov_b32 s15, 0x00020000
    s_mov_b32 s16, s6
    s_and_b32 s17, s7, 0xffff
    s_mov_b32 s18, 819200
    s_mov_b32 s19, 0x00020000
    s_mov_b32 s32, s30
    s_and_b32 s33, s31, 0xffff
    s_mov_b32 s34, 2621440
    s_mov_b32 s35, 0x00020000
    s_mov_b32 s36, s26
    s_and_b32 s37, s27, 0xffff
    s_mov_b32 s38, 2621440
    s_mov_b32 s39, 0x00020000
    s_sub_u32 s21, s20, 8
    s_and_b32 s23, s2, 7
    s_lshr_b32 s25, s2, 3
    s_lshr_b32 s22, s25, 2
    s_lshl_b32 s23, s23, 3
    s_add_u32 s22, s22, s23
    s_and_b32 s25, s25, 3
    v_lshlrev_b32 v4, 4, v2
    v_add_u32 v156, 0, v2
    v_mul_u32_u24 v157, 52429, v156
    v_lshrrev_b32 v157, 20, v157
    v_mul_u32_u24 v158, 20, v157
    v_sub_u32 v158, v156, v158
    v_mul_u32_u24 v159, 1280, v157
    v_lshl_add_u32 v5, v158, 4, v159
    v_bfe_u32 v159, v157, 2, 1
    v_lshlrev_b32 v159, 1, v159
    v_bfe_u32 v160, v157, 3, 1
    v_add_u32 v159, v159, v160
    v_mul_u32_u24 v159, 20, v159
    v_and_b32 v160, 3, v157
    v_add_u32 v159, v159, v160
    v_mul_u32_u24 v159, 1280, v159
    v_lshl_add_u32 v10, v158, 4, v159
    v_add_u32 v156, 64, v2
    v_mul_u32_u24 v157, 52429, v156
    v_lshrrev_b32 v157, 20, v157
    v_mul_u32_u24 v158, 20, v157
    v_sub_u32 v158, v156, v158
    v_mul_u32_u24 v159, 1280, v157
    v_lshl_add_u32 v6, v158, 4, v159
    v_bfe_u32 v159, v157, 2, 1
    v_lshlrev_b32 v159, 1, v159
    v_bfe_u32 v160, v157, 3, 1
    v_add_u32 v159, v159, v160
    v_mul_u32_u24 v159, 20, v159
    v_and_b32 v160, 3, v157
    v_add_u32 v159, v159, v160
    v_mul_u32_u24 v159, 1280, v159
    v_lshl_add_u32 v11, v158, 4, v159
    v_add_u32 v156, 128, v2
    v_mul_u32_u24 v157, 52429, v156
    v_lshrrev_b32 v157, 20, v157
    v_mul_u32_u24 v158, 20, v157
    v_sub_u32 v158, v156, v158
    v_mul_u32_u24 v159, 1280, v157
    v_lshl_add_u32 v7, v158, 4, v159
    v_bfe_u32 v159, v157, 2, 1
    v_lshlrev_b32 v159, 1, v159
    v_bfe_u32 v160, v157, 3, 1
    v_add_u32 v159, v159, v160
    v_mul_u32_u24 v159, 20, v159
    v_and_b32 v160, 3, v157
    v_add_u32 v159, v159, v160
    v_mul_u32_u24 v159, 1280, v159
    v_lshl_add_u32 v12, v158, 4, v159
    v_add_u32 v156, 192, v2
    v_mul_u32_u24 v157, 52429, v156
    v_lshrrev_b32 v157, 20, v157
    v_mul_u32_u24 v158, 20, v157
    v_sub_u32 v158, v156, v158
    v_mul_u32_u24 v159, 1280, v157
    v_lshl_add_u32 v8, v158, 4, v159
    v_bfe_u32 v159, v157, 2, 1
    v_lshlrev_b32 v159, 1, v159
    v_bfe_u32 v160, v157, 3, 1
    v_add_u32 v159, v159, v160
    v_mul_u32_u24 v159, 20, v159
    v_and_b32 v160, 3, v157
    v_add_u32 v159, v159, v160
    v_mul_u32_u24 v159, 1280, v159
    v_lshl_add_u32 v13, v158, 4, v159
    v_add_u32 v156, 256, v2
    v_mul_u32_u24 v157, 52429, v156
    v_lshrrev_b32 v157, 20, v157
    v_mul_u32_u24 v158, 20, v157
    v_sub_u32 v158, v156, v158
    v_mul_u32_u24 v159, 1280, v157
    v_lshl_add_u32 v9, v158, 4, v159
    v_bfe_u32 v159, v157, 2, 1
    v_lshlrev_b32 v159, 1, v159
    v_bfe_u32 v160, v157, 3, 1
    v_add_u32 v159, v159, v160
    v_mul_u32_u24 v159, 20, v159
    v_and_b32 v160, 3, v157
    v_add_u32 v159, v159, v160
    v_mul_u32_u24 v159, 1280, v159
    v_lshl_add_u32 v14, v158, 4, v159
    v_lshrrev_b32 v156, 5, v2
    v_bfe_u32 v157, v2, 2, 2
    v_lshl_add_u32 v156, v156, 2, v157
    v_mul_u32_u24 v3, 320, v156
    v_bfe_u32 v156, v2, 4, 1
    v_lshl_add_u32 v3, v156, 5, v3
    v_and_b32 v156, 3, v2
    v_lshl_add_u32 v3, v156, 3, v3
    s_mul_i32 s40, s21, 20992
    s_add_u32 s40, s40, 65280
    v_add_u32 v3, s40, v3
    s_mul_i32 s46, s22, 40960
    s_mul_i32 s24, s25, 320
    s_add_u32 s46, s46, s24
    s_mul_i32 s41, s21, 491520
    s_add_u32 s41, s41, s24
    s_mul_i32 s43, s22, 96
    s_mul_i32 s23, s21, 24
    s_add_u32 s43, s43, s23
    s_lshl_b32 s43, s43, 10
    s_add_u32 s43, s43, 13631488
    s_mov_b32 s47, s41
    s_mov_b32 s48, s43
    s_add_u32 m0, s40, 0
    s_add_u32 s23, s47, 0
    buffer_load_dwordx4 v5, s[12:15], s23 offen lds
    s_add_u32 m0, s40, 1024
    s_add_u32 s23, s47, 0
    buffer_load_dwordx4 v6, s[12:15], s23 offen lds
    s_add_u32 m0, s40, 2048
    s_add_u32 s23, s47, 0
    buffer_load_dwordx4 v7, s[12:15], s23 offen lds
    s_add_u32 m0, s40, 3072
    s_add_u32 s23, s47, 0
    buffer_load_dwordx4 v8, s[12:15], s23 offen lds
    s_add_u32 m0, s40, 4096
    s_add_u32 s23, s47, 0
    buffer_load_dwordx4 v9, s[12:15], s23 offen lds
    buffer_load_dwordx4 v[16:19], v4, s[8:11], s48 offen
    s_add_u32 s47, s47, 20480
    s_add_u32 s48, s48, 1024
    s_add_u32 m0, s40, 5120
    s_add_u32 s23, s47, 0
    buffer_load_dwordx4 v5, s[12:15], s23 offen lds
    s_add_u32 m0, s40, 6144
    s_add_u32 s23, s47, 0
    buffer_load_dwordx4 v6, s[12:15], s23 offen lds
    s_add_u32 m0, s40, 7168
    s_add_u32 s23, s47, 0
    buffer_load_dwordx4 v7, s[12:15], s23 offen lds
    s_add_u32 m0, s40, 8192
    s_add_u32 s23, s47, 0
    buffer_load_dwordx4 v8, s[12:15], s23 offen lds
    s_add_u32 m0, s40, 9216
    s_add_u32 s23, s47, 0
    buffer_load_dwordx4 v9, s[12:15], s23 offen lds
    buffer_load_dwordx4 v[20:23], v4, s[8:11], s48 offen
    s_add_u32 s47, s47, 20480
    s_add_u32 s48, s48, 1024
    s_add_u32 m0, s40, 10240
    s_add_u32 s23, s47, 0
    buffer_load_dwordx4 v5, s[12:15], s23 offen lds
    s_add_u32 m0, s40, 11264
    s_add_u32 s23, s47, 0
    buffer_load_dwordx4 v6, s[12:15], s23 offen lds
    s_add_u32 m0, s40, 12288
    s_add_u32 s23, s47, 0
    buffer_load_dwordx4 v7, s[12:15], s23 offen lds
    s_add_u32 m0, s40, 13312
    s_add_u32 s23, s47, 0
    buffer_load_dwordx4 v8, s[12:15], s23 offen lds
    s_add_u32 m0, s40, 14336
    s_add_u32 s23, s47, 0
    buffer_load_dwordx4 v9, s[12:15], s23 offen lds
    buffer_load_dwordx4 v[24:27], v4, s[8:11], s48 offen
    s_add_u32 s47, s47, 20480
    s_add_u32 s48, s48, 1024
    v_mov_b32 v52, 0
    v_mov_b32 v53, 0
    v_mov_b32 v54, 0
    v_mov_b32 v55, 0
    v_mov_b32 v56, 0
    v_mov_b32 v57, 0
    v_mov_b32 v58, 0
    v_mov_b32 v59, 0
    v_mov_b32 v60, 0
    v_mov_b32 v61, 0
    v_mov_b32 v62, 0
    v_mov_b32 v63, 0
    v_mov_b32 v64, 0
    v_mov_b32 v65, 0
    v_mov_b32 v66, 0
    v_mov_b32 v67, 0
    v_mov_b32 v68, 0
    v_mov_b32 v69, 0
    v_mov_b32 v70, 0
    v_mov_b32 v71, 0
    v_mov_b32 v72, 0
    v_mov_b32 v73, 0
    v_mov_b32 v74, 0
    v_mov_b32 v75, 0
    v_mov_b32 v76, 0
    v_mov_b32 v77, 0
    v_mov_b32 v78, 0
    v_mov_b32 v79, 0
    v_mov_b32 v80, 0
    v_mov_b32 v81, 0
    v_mov_b32 v82, 0
    v_mov_b32 v83, 0
    v_mov_b32 v84, 0
    v_mov_b32 v85, 0
    v_mov_b32 v86, 0
    v_mov_b32 v87, 0
    v_mov_b32 v88, 0
    v_mov_b32 v89, 0
    v_mov_b32 v90, 0
    v_mov_b32 v91, 0
    v_mov_b32 v92, 0
    v_mov_b32 v93, 0
    v_mov_b32 v94, 0
    v_mov_b32 v95, 0
    v_mov_b32 v96, 0
    v_mov_b32 v97, 0
    v_mov_b32 v98, 0
    v_mov_b32 v99, 0
    v_mov_b32 v100, 0
    v_mov_b32 v101, 0
    v_mov_b32 v102, 0
    v_mov_b32 v103, 0
    v_mov_b32 v104, 0
    v_mov_b32 v105, 0
    v_mov_b32 v106, 0
    v_mov_b32 v107, 0
    v_mov_b32 v108, 0
    v_mov_b32 v109, 0
    v_mov_b32 v110, 0
    v_mov_b32 v111, 0
    v_mov_b32 v112, 0
    v_mov_b32 v113, 0
    v_mov_b32 v114, 0
    v_mov_b32 v115, 0
    v_mov_b32 v116, 0
    v_mov_b32 v117, 0
    v_mov_b32 v118, 0
    v_mov_b32 v119, 0
    v_mov_b32 v120, 0
    v_mov_b32 v121, 0
    v_mov_b32 v122, 0
    v_mov_b32 v123, 0
    v_mov_b32 v124, 0
    v_mov_b32 v125, 0
    v_mov_b32 v126, 0
    v_mov_b32 v127, 0
    v_mov_b32 v128, 0
    v_mov_b32 v129, 0
    v_mov_b32 v130, 0
    v_mov_b32 v131, 0
    v_and_b32 v156, 31, v2
    v_mul_u32_u24 v156, 1280, v156
    v_lshrrev_b32 v157, 5, v2
    v_lshl_add_u32 v156, v157, 3, v156
    s_lshl_b32 s24, s21, 4
    s_add_u32 s24, s24, s46
    buffer_load_dwordx2 v[132:133], v156, s[32:35], s24 offen offset:0
    buffer_load_dwordx2 v[134:135], v156, s[32:35], s24 offen offset:64
    buffer_load_dwordx2 v[136:137], v156, s[32:35], s24 offen offset:128
    buffer_load_dwordx2 v[138:139], v156, s[32:35], s24 offen offset:192
    buffer_load_dwordx2 v[140:141], v156, s[32:35], s24 offen offset:256
    s_waitcnt vmcnt(0)
    s_cmp_lg_u32 s21, 0
    s_cbranch_scc1 L_main_res0
    v_lshlrev_b32 v52, 16, v132
    v_and_b32 v53, 0xffff0000, v132
    v_lshlrev_b32 v54, 16, v133
    v_and_b32 v55, 0xffff0000, v133
    v_lshlrev_b32 v68, 16, v134
    v_and_b32 v69, 0xffff0000, v134
    v_lshlrev_b32 v70, 16, v135
    v_and_b32 v71, 0xffff0000, v135
    v_lshlrev_b32 v84, 16, v136
    v_and_b32 v85, 0xffff0000, v136
    v_lshlrev_b32 v86, 16, v137
    v_and_b32 v87, 0xffff0000, v137
    v_lshlrev_b32 v100, 16, v138
    v_and_b32 v101, 0xffff0000, v138
    v_lshlrev_b32 v102, 16, v139
    v_and_b32 v103, 0xffff0000, v139
    v_lshlrev_b32 v116, 16, v140
    v_and_b32 v117, 0xffff0000, v140
    v_lshlrev_b32 v118, 16, v141
    v_and_b32 v119, 0xffff0000, v141
    s_branch L_main_resdone
L_main_res0:
    s_cmp_lg_u32 s21, 1
    s_cbranch_scc1 L_main_res1
    v_lshlrev_b32 v56, 16, v132
    v_and_b32 v57, 0xffff0000, v132
    v_lshlrev_b32 v58, 16, v133
    v_and_b32 v59, 0xffff0000, v133
    v_lshlrev_b32 v72, 16, v134
    v_and_b32 v73, 0xffff0000, v134
    v_lshlrev_b32 v74, 16, v135
    v_and_b32 v75, 0xffff0000, v135
    v_lshlrev_b32 v88, 16, v136
    v_and_b32 v89, 0xffff0000, v136
    v_lshlrev_b32 v90, 16, v137
    v_and_b32 v91, 0xffff0000, v137
    v_lshlrev_b32 v104, 16, v138
    v_and_b32 v105, 0xffff0000, v138
    v_lshlrev_b32 v106, 16, v139
    v_and_b32 v107, 0xffff0000, v139
    v_lshlrev_b32 v120, 16, v140
    v_and_b32 v121, 0xffff0000, v140
    v_lshlrev_b32 v122, 16, v141
    v_and_b32 v123, 0xffff0000, v141
    s_branch L_main_resdone
L_main_res1:
    s_cmp_lg_u32 s21, 2
    s_cbranch_scc1 L_main_res2
    v_lshlrev_b32 v60, 16, v132
    v_and_b32 v61, 0xffff0000, v132
    v_lshlrev_b32 v62, 16, v133
    v_and_b32 v63, 0xffff0000, v133
    v_lshlrev_b32 v76, 16, v134
    v_and_b32 v77, 0xffff0000, v134
    v_lshlrev_b32 v78, 16, v135
    v_and_b32 v79, 0xffff0000, v135
    v_lshlrev_b32 v92, 16, v136
    v_and_b32 v93, 0xffff0000, v136
    v_lshlrev_b32 v94, 16, v137
    v_and_b32 v95, 0xffff0000, v137
    v_lshlrev_b32 v108, 16, v138
    v_and_b32 v109, 0xffff0000, v138
    v_lshlrev_b32 v110, 16, v139
    v_and_b32 v111, 0xffff0000, v139
    v_lshlrev_b32 v124, 16, v140
    v_and_b32 v125, 0xffff0000, v140
    v_lshlrev_b32 v126, 16, v141
    v_and_b32 v127, 0xffff0000, v141
    s_branch L_main_resdone
L_main_res2:
    v_lshlrev_b32 v64, 16, v132
    v_and_b32 v65, 0xffff0000, v132
    v_lshlrev_b32 v66, 16, v133
    v_and_b32 v67, 0xffff0000, v133
    v_lshlrev_b32 v80, 16, v134
    v_and_b32 v81, 0xffff0000, v134
    v_lshlrev_b32 v82, 16, v135
    v_and_b32 v83, 0xffff0000, v135
    v_lshlrev_b32 v96, 16, v136
    v_and_b32 v97, 0xffff0000, v136
    v_lshlrev_b32 v98, 16, v137
    v_and_b32 v99, 0xffff0000, v137
    v_lshlrev_b32 v112, 16, v138
    v_and_b32 v113, 0xffff0000, v138
    v_lshlrev_b32 v114, 16, v139
    v_and_b32 v115, 0xffff0000, v139
    v_lshlrev_b32 v128, 16, v140
    v_and_b32 v129, 0xffff0000, v140
    v_lshlrev_b32 v130, 16, v141
    v_and_b32 v131, 0xffff0000, v141
L_main_resdone:
    ds_read_b64_tr_b16 v[32:33], v3 offset:0
    ds_read_b64_tr_b16 v[34:35], v3 offset:2560
    ds_read_b64_tr_b16 v[36:37], v3 offset:64
    ds_read_b64_tr_b16 v[38:39], v3 offset:2624
    ds_read_b64_tr_b16 v[40:41], v3 offset:128
    ds_read_b64_tr_b16 v[42:43], v3 offset:2688
    ds_read_b64_tr_b16 v[44:45], v3 offset:192
    ds_read_b64_tr_b16 v[46:47], v3 offset:2752
    ds_read_b64_tr_b16 v[48:49], v3 offset:256
    ds_read_b64_tr_b16 v[50:51], v3 offset:2816
    s_mov_b32 s49, 6
L_main_hloop:
    s_waitcnt vmcnt(6)
    s_waitcnt lgkmcnt(8)
    v_mfma_f32_32x32x16_bf16 v[52:67], v[32:35], v[16:19], v[52:67]
    ds_read_b64_tr_b16 v[32:33], v3 offset:5120
    ds_read_b64_tr_b16 v[34:35], v3 offset:7680
    s_waitcnt lgkmcnt(8)
    v_mfma_f32_32x32x16_bf16 v[68:83], v[36:39], v[16:19], v[68:83]
    ds_read_b64_tr_b16 v[36:37], v3 offset:5184
    ds_read_b64_tr_b16 v[38:39], v3 offset:7744
    s_waitcnt lgkmcnt(8)
    v_mfma_f32_32x32x16_bf16 v[84:99], v[40:43], v[16:19], v[84:99]
    ds_read_b64_tr_b16 v[40:41], v3 offset:5248
    ds_read_b64_tr_b16 v[42:43], v3 offset:7808
    s_waitcnt lgkmcnt(8)
    v_mfma_f32_32x32x16_bf16 v[100:115], v[44:47], v[16:19], v[100:115]
    ds_read_b64_tr_b16 v[44:45], v3 offset:5312
    ds_read_b64_tr_b16 v[46:47], v3 offset:7872
    s_waitcnt lgkmcnt(8)
    v_mfma_f32_32x32x16_bf16 v[116:131], v[48:51], v[16:19], v[116:131]
    ds_read_b64_tr_b16 v[48:49], v3 offset:5376
    ds_read_b64_tr_b16 v[50:51], v3 offset:7936
    s_add_u32 m0, s40, 15360
    s_add_u32 s23, s47, 0
    buffer_load_dwordx4 v5, s[12:15], s23 offen lds
    s_add_u32 m0, s40, 16384
    s_add_u32 s23, s47, 0
    buffer_load_dwordx4 v6, s[12:15], s23 offen lds
    s_add_u32 m0, s40, 17408
    s_add_u32 s23, s47, 0
    buffer_load_dwordx4 v7, s[12:15], s23 offen lds
    s_add_u32 m0, s40, 18432
    s_add_u32 s23, s47, 0
    buffer_load_dwordx4 v8, s[12:15], s23 offen lds
    s_add_u32 m0, s40, 19456
    s_add_u32 s23, s47, 0
    buffer_load_dwordx4 v9, s[12:15], s23 offen lds
    buffer_load_dwordx4 v[28:31], v4, s[8:11], s48 offen
    s_add_u32 s47, s47, 20480
    s_add_u32 s48, s48, 1024
    s_waitcnt vmcnt(6)
    s_waitcnt lgkmcnt(8)
    v_mfma_f32_32x32x16_bf16 v[52:67], v[32:35], v[20:23], v[52:67]
    ds_read_b64_tr_b16 v[32:33], v3 offset:10240
    ds_read_b64_tr_b16 v[34:35], v3 offset:12800
    s_waitcnt lgkmcnt(8)
    v_mfma_f32_32x32x16_bf16 v[68:83], v[36:39], v[20:23], v[68:83]
    ds_read_b64_tr_b16 v[36:37], v3 offset:10304
    ds_read_b64_tr_b16 v[38:39], v3 offset:12864
    s_waitcnt lgkmcnt(8)
    v_mfma_f32_32x32x16_bf16 v[84:99], v[40:43], v[20:23], v[84:99]
    ds_read_b64_tr_b16 v[40:41], v3 offset:10368
    ds_read_b64_tr_b16 v[42:43], v3 offset:12928
    s_waitcnt lgkmcnt(8)
    v_mfma_f32_32x32x16_bf16 v[100:115], v[44:47], v[20:23], v[100:115]
    ds_read_b64_tr_b16 v[44:45], v3 offset:10432
    ds_read_b64_tr_b16 v[46:47], v3 offset:12992
    s_waitcnt lgkmcnt(8)
    v_mfma_f32_32x32x16_bf16 v[116:131], v[48:51], v[20:23], v[116:131]
    ds_read_b64_tr_b16 v[48:49], v3 offset:10496
    ds_read_b64_tr_b16 v[50:51], v3 offset:13056
    s_add_u32 m0, s40, 0
    s_add_u32 s23, s47, 0
    buffer_load_dwordx4 v5, s[12:15], s23 offen lds
    s_add_u32 m0, s40, 1024
    s_add_u32 s23, s47, 0
    buffer_load_dwordx4 v6, s[12:15], s23 offen lds
    s_add_u32 m0, s40, 2048
    s_add_u32 s23, s47, 0
    buffer_load_dwordx4 v7, s[12:15], s23 offen lds
    s_add_u32 m0, s40, 3072
    s_add_u32 s23, s47, 0
    buffer_load_dwordx4 v8, s[12:15], s23 offen lds
    s_add_u32 m0, s40, 4096
    s_add_u32 s23, s47, 0
    buffer_load_dwordx4 v9, s[12:15], s23 offen lds
    buffer_load_dwordx4 v[16:19], v4, s[8:11], s48 offen
    s_add_u32 s47, s47, 20480
    s_add_u32 s48, s48, 1024
    s_waitcnt vmcnt(6)
    s_waitcnt lgkmcnt(8)
    v_mfma_f32_32x32x16_bf16 v[52:67], v[32:35], v[24:27], v[52:67]
    ds_read_b64_tr_b16 v[32:33], v3 offset:15360
    ds_read_b64_tr_b16 v[34:35], v3 offset:17920
    s_waitcnt lgkmcnt(8)
    v_mfma_f32_32x32x16_bf16 v[68:83], v[36:39], v[24:27], v[68:83]
    ds_read_b64_tr_b16 v[36:37], v3 offset:15424
    ds_read_b64_tr_b16 v[38:39], v3 offset:17984
    s_waitcnt lgkmcnt(8)
    v_mfma_f32_32x32x16_bf16 v[84:99], v[40:43], v[24:27], v[84:99]
    ds_read_b64_tr_b16 v[40:41], v3 offset:15488
    ds_read_b64_tr_b16 v[42:43], v3 offset:18048
    s_waitcnt lgkmcnt(8)
    v_mfma_f32_32x32x16_bf16 v[100:115], v[44:47], v[24:27], v[100:115]
    ds_read_b64_tr_b16 v[44:45], v3 offset:15552
    ds_read_b64_tr_b16 v[46:47], v3 offset:18112
    s_waitcnt lgkmcnt(8)
    v_mfma_f32_32x32x16_bf16 v[116:131], v[48:51], v[24:27], v[116:131]
    ds_read_b64_tr_b16 v[48:49], v3 offset:15616
    ds_read_b64_tr_b16 v[50:51], v3 offset:18176
    s_add_u32 m0, s40, 5120
    s_add_u32 s23, s47, 0
    buffer_load_dwordx4 v5, s[12:15], s23 offen lds
    s_add_u32 m0, s40, 6144
    s_add_u32 s23, s47, 0
    buffer_load_dwordx4 v6, s[12:15], s23 offen lds
    s_add_u32 m0, s40, 7168
    s_add_u32 s23, s47, 0
    buffer_load_dwordx4 v7, s[12:15], s23 offen lds
    s_add_u32 m0, s40, 8192
    s_add_u32 s23, s47, 0
    buffer_load_dwordx4 v8, s[12:15], s23 offen lds
    s_add_u32 m0, s40, 9216
    s_add_u32 s23, s47, 0
    buffer_load_dwordx4 v9, s[12:15], s23 offen lds
    buffer_load_dwordx4 v[20:23], v4, s[8:11], s48 offen
    s_add_u32 s47, s47, 20480
    s_add_u32 s48, s48, 1024
    s_waitcnt vmcnt(6)
    s_waitcnt lgkmcnt(8)
    v_mfma_f32_32x32x16_bf16 v[52:67], v[32:35], v[28:31], v[52:67]
    ds_read_b64_tr_b16 v[32:33], v3 offset:0
    ds_read_b64_tr_b16 v[34:35], v3 offset:2560
    s_waitcnt lgkmcnt(8)
    v_mfma_f32_32x32x16_bf16 v[68:83], v[36:39], v[28:31], v[68:83]
    ds_read_b64_tr_b16 v[36:37], v3 offset:64
    ds_read_b64_tr_b16 v[38:39], v3 offset:2624
    s_waitcnt lgkmcnt(8)
    v_mfma_f32_32x32x16_bf16 v[84:99], v[40:43], v[28:31], v[84:99]
    ds_read_b64_tr_b16 v[40:41], v3 offset:128
    ds_read_b64_tr_b16 v[42:43], v3 offset:2688
    s_waitcnt lgkmcnt(8)
    v_mfma_f32_32x32x16_bf16 v[100:115], v[44:47], v[28:31], v[100:115]
    ds_read_b64_tr_b16 v[44:45], v3 offset:192
    ds_read_b64_tr_b16 v[46:47], v3 offset:2752
    s_waitcnt lgkmcnt(8)
    v_mfma_f32_32x32x16_bf16 v[116:131], v[48:51], v[28:31], v[116:131]
    ds_read_b64_tr_b16 v[48:49], v3 offset:256
    ds_read_b64_tr_b16 v[50:51], v3 offset:2816
    s_add_u32 m0, s40, 10240
    s_add_u32 s23, s47, 0
    buffer_load_dwordx4 v5, s[12:15], s23 offen lds
    s_add_u32 m0, s40, 11264
    s_add_u32 s23, s47, 0
    buffer_load_dwordx4 v6, s[12:15], s23 offen lds
    s_add_u32 m0, s40, 12288
    s_add_u32 s23, s47, 0
    buffer_load_dwordx4 v7, s[12:15], s23 offen lds
    s_add_u32 m0, s40, 13312
    s_add_u32 s23, s47, 0
    buffer_load_dwordx4 v8, s[12:15], s23 offen lds
    s_add_u32 m0, s40, 14336
    s_add_u32 s23, s47, 0
    buffer_load_dwordx4 v9, s[12:15], s23 offen lds
    buffer_load_dwordx4 v[24:27], v4, s[8:11], s48 offen
    s_add_u32 s47, s47, 20480
    s_add_u32 s48, s48, 1024
    s_sub_u32 s49, s49, 1
    s_cmp_lg_u32 s49, 0
    s_cbranch_scc1 L_main_hloop
    s_waitcnt vmcnt(0) lgkmcnt(0)
    s_mul_i32 s24, s25, 320
    s_mul_i32 s41, s21, 204800
    s_add_u32 s41, s41, s24
    s_add_u32 s42, s41, 20480
    s_lshl_b32 s43, s22, 5
    s_lshl_b32 s23, s21, 3
    s_add_u32 s23, s23, s43
    s_lshl_b32 s44, s23, 10
    s_add_u32 s44, s44, 20971520
    s_lshl_b32 s45, s23, 8
    s_add_u32 s45, s45, 23068672
    v_and_b32 v158, 31, v2
    v_lshlrev_b32 v158, 3, v158
    v_lshrrev_b32 v159, 5, v2
    v_lshl_add_u32 v158, v159, 9, v158
    s_add_u32 m0, s40, 0
    s_add_u32 s23, s41, 0
    buffer_load_dwordx4 v5, s[16:19], s23 offen lds
    s_add_u32 m0, s40, 1024
    s_add_u32 s23, s41, 0
    buffer_load_dwordx4 v6, s[16:19], s23 offen lds
    s_add_u32 m0, s40, 2048
    s_add_u32 s23, s41, 0
    buffer_load_dwordx4 v7, s[16:19], s23 offen lds
    s_add_u32 m0, s40, 3072
    s_add_u32 s23, s41, 0
    buffer_load_dwordx4 v8, s[16:19], s23 offen lds
    s_add_u32 m0, s40, 4096
    s_add_u32 s23, s41, 0
    buffer_load_dwordx4 v9, s[16:19], s23 offen lds
    s_add_u32 m0, s40, 5120
    s_add_u32 s23, s41, 25600
    buffer_load_dwordx4 v5, s[16:19], s23 offen lds
    s_add_u32 m0, s40, 6144
    s_add_u32 s23, s41, 25600
    buffer_load_dwordx4 v6, s[16:19], s23 offen lds
    s_add_u32 m0, s40, 7168
    s_add_u32 s23, s41, 25600
    buffer_load_dwordx4 v7, s[16:19], s23 offen lds
    s_add_u32 m0, s40, 8192
    s_add_u32 s23, s41, 25600
    buffer_load_dwordx4 v8, s[16:19], s23 offen lds
    s_add_u32 m0, s40, 9216
    s_add_u32 s23, s41, 25600
    buffer_load_dwordx4 v9, s[16:19], s23 offen lds
    s_add_u32 m0, s40, 10240
    s_add_u32 s23, s41, 51200
    buffer_load_dwordx4 v5, s[16:19], s23 offen lds
    s_add_u32 m0, s40, 11264
    s_add_u32 s23, s41, 51200
    buffer_load_dwordx4 v6, s[16:19], s23 offen lds
    s_add_u32 m0, s40, 12288
    s_add_u32 s23, s41, 51200
    buffer_load_dwordx4 v7, s[16:19], s23 offen lds
    s_add_u32 m0, s40, 13312
    s_add_u32 s23, s41, 51200
    buffer_load_dwordx4 v8, s[16:19], s23 offen lds
    s_add_u32 m0, s40, 14336
    s_add_u32 s23, s41, 51200
    buffer_load_dwordx4 v9, s[16:19], s23 offen lds
    s_add_u32 m0, s40, 15360
    s_add_u32 s23, s41, 76800
    buffer_load_dwordx4 v5, s[16:19], s23 offen lds
    s_add_u32 m0, s40, 16384
    s_add_u32 s23, s41, 76800
    buffer_load_dwordx4 v6, s[16:19], s23 offen lds
    s_add_u32 m0, s40, 17408
    s_add_u32 s23, s41, 76800
    buffer_load_dwordx4 v7, s[16:19], s23 offen lds
    s_add_u32 m0, s40, 18432
    s_add_u32 s23, s41, 76800
    buffer_load_dwordx4 v8, s[16:19], s23 offen lds
    s_add_u32 m0, s40, 19456
    s_add_u32 s23, s41, 76800
    buffer_load_dwordx4 v9, s[16:19], s23 offen lds
    s_add_u32 s23, s41, 179200
    buffer_load_dwordx4 v[132:135], v5, s[16:19], s23 offen
    s_add_u32 s23, s41, 179200
    buffer_load_dwordx4 v[132:135], v6, s[16:19], s23 offen
    s_add_u32 s23, s41, 179200
    buffer_load_dwordx4 v[132:135], v7, s[16:19], s23 offen
    s_add_u32 s23, s41, 179200
    buffer_load_dwordx4 v[132:135], v8, s[16:19], s23 offen
    s_add_u32 s23, s41, 179200
    buffer_load_dwordx4 v[132:135], v9, s[16:19], s23 offen
    s_add_u32 s23, s42, 0
    buffer_load_dwordx4 v[132:135], v10, s[16:19], s23 offen
    s_add_u32 s23, s42, 0
    buffer_load_dwordx4 v[132:135], v11, s[16:19], s23 offen
    s_add_u32 s23, s42, 0
    buffer_load_dwordx4 v[132:135], v12, s[16:19], s23 offen
    s_add_u32 s23, s42, 0
    buffer_load_dwordx4 v[132:135], v13, s[16:19], s23 offen
    s_add_u32 s23, s42, 0
    buffer_load_dwordx4 v[132:135], v14, s[16:19], s23 offen
    s_add_u32 s23, s42, 102400
    buffer_load_dwordx4 v[132:135], v10, s[16:19], s23 offen
    s_add_u32 s23, s42, 102400
    buffer_load_dwordx4 v[132:135], v11, s[16:19], s23 offen
    s_add_u32 s23, s42, 102400
    buffer_load_dwordx4 v[132:135], v12, s[16:19], s23 offen
    s_add_u32 s23, s42, 102400
    buffer_load_dwordx4 v[132:135], v13, s[16:19], s23 offen
    s_add_u32 s23, s42, 102400
    buffer_load_dwordx4 v[132:135], v14, s[16:19], s23 offen
    s_mul_i32 s47, s21, 15360
    v_subrev_u32 v161, s40, v3
    v_add_u32 v161, s47, v161
    v_mov_b32 v162, 65092
    s_mov_b32 s24, 8
    s_mov_b32 s78, 0x40000
L_wait_own:
    ds_read_b32 v163, v162
    s_waitcnt lgkmcnt(0)
    v_readfirstlane_b32 s50, v163
    s_sub_u32 s78, s78, 1
    s_cbranch_scc1 L_go_own
    s_cmp_ge_u32 s50, s24
    s_cbranch_scc1 L_go_own
    s_sleep 1
    s_branch L_wait_own
L_go_own:
    s_add_u32 m0, s47, 0
    s_add_u32 s23, s41, 102400
    buffer_load_dwordx4 v5, s[16:19], s23 offen lds
    s_add_u32 m0, s47, 1024
    s_add_u32 s23, s41, 102400
    buffer_load_dwordx4 v6, s[16:19], s23 offen lds
    s_add_u32 m0, s47, 2048
    s_add_u32 s23, s41, 102400
    buffer_load_dwordx4 v7, s[16:19], s23 offen lds
    s_add_u32 m0, s47, 3072
    s_add_u32 s23, s41, 102400
    buffer_load_dwordx4 v8, s[16:19], s23 offen lds
    s_add_u32 m0, s47, 4096
    s_add_u32 s23, s41, 102400
    buffer_load_dwordx4 v9, s[16:19], s23 offen lds
    s_add_u32 m0, s47, 5120
    s_add_u32 s23, s41, 128000
    buffer_load_dwordx4 v5, s[16:19], s23 offen lds
    s_add_u32 m0, s47, 6144
    s_add_u32 s23, s41, 128000
    buffer_load_dwordx4 v6, s[16:19], s23 offen lds
    s_add_u32 m0, s47, 7168
    s_add_u32 s23, s41, 128000
    buffer_load_dwordx4 v7, s[16:19], s23 offen lds
    s_add_u32 m0, s47, 8192
    s_add_u32 s23, s41, 128000
    buffer_load_dwordx4 v8, s[16:19], s23 offen lds
    s_add_u32 m0, s47, 9216
    s_add_u32 s23, s41, 128000
    buffer_load_dwordx4 v9, s[16:19], s23 offen lds
    s_add_u32 m0, s47, 10240
    s_add_u32 s23, s41, 153600
    buffer_load_dwordx4 v5, s[16:19], s23 offen lds
    s_add_u32 m0, s47, 11264
    s_add_u32 s23, s41, 153600
    buffer_load_dwordx4 v6, s[16:19], s23 offen lds
    s_add_u32 m0, s47, 12288
    s_add_u32 s23, s41, 153600
    buffer_load_dwordx4 v7, s[16:19], s23 offen lds
    s_add_u32 m0, s47, 13312
    s_add_u32 s23, s41, 153600
    buffer_load_dwordx4 v8, s[16:19], s23 offen lds
    s_add_u32 m0, s47, 14336
    s_add_u32 s23, s41, 153600
    buffer_load_dwordx4 v9, s[16:19], s23 offen lds
    s_waitcnt vmcnt(0)
    ds_read_b64_tr_b16 v[32:33], v3 offset:0
    ds_read_b64_tr_b16 v[34:35], v3 offset:2560
    ds_read_b64_tr_b16 v[36:37], v3 offset:64
    ds_read_b64_tr_b16 v[38:39], v3 offset:2624
    ds_read_b64_tr_b16 v[40:41], v3 offset:128
    ds_read_b64_tr_b16 v[42:43], v3 offset:2688
    ds_read_b64_tr_b16 v[44:45], v3 offset:192
    ds_read_b64_tr_b16 v[46:47], v3 offset:2752
    ds_read_b64_tr_b16 v[48:49], v3 offset:256
    ds_read_b64_tr_b16 v[50:51], v3 offset:2816
    s_lshr_b32 s24, s22, 3
    s_lshl_b32 s24, s24, 8
    s_add_u32 s24, s24, 24117248
    s_mov_b32 s78, 0x10000
    v_mov_b32 v157, 0
    buffer_load_dword v156, v157, s[8:11], s24 offen sc1
L_gw_o:
    s_sleep 3
    buffer_load_dword v160, v157, s[8:11], s24 offen sc1
    s_waitcnt vmcnt(1)
    v_readfirstlane_b32 s50, v156
    s_sub_u32 s78, s78, 1
    s_cbranch_scc1 L_gg_o
    s_cmp_ge_u32 s50, 32
    s_cbranch_scc1 L_gg_o
    s_sleep 3
    buffer_load_dword v156, v157, s[8:11], s24 offen sc1
    s_waitcnt vmcnt(1)
    v_readfirstlane_b32 s50, v160
    s_sub_u32 s78, s78, 1
    s_cbranch_scc1 L_gg_o
    s_cmp_ge_u32 s50, 32
    s_cbranch_scc1 L_gg_o
    s_branch L_gw_o
L_gg_o:
    s_add_u32 s23, s44, 0
    buffer_load_dwordx4 v[16:19], v4, s[8:11], s23 offen sc1
    s_add_u32 s23, s44, 1024
    buffer_load_dwordx4 v[20:23], v4, s[8:11], s23 offen sc1
    s_add_u32 s23, s44, 2048
    buffer_load_dwordx4 v[24:27], v4, s[8:11], s23 offen sc1
    s_add_u32 s23, s44, 3072
    buffer_load_dwordx4 v[28:31], v4, s[8:11], s23 offen sc1
    s_add_u32 s23, s44, 4096
    buffer_load_dwordx4 v[132:135], v4, s[8:11], s23 offen sc1
    s_add_u32 s23, s44, 5120
    buffer_load_dwordx4 v[136:139], v4, s[8:11], s23 offen sc1
    s_add_u32 s23, s44, 6144
    buffer_load_dwordx4 v[140:143], v4, s[8:11], s23 offen sc1
    s_add_u32 s23, s44, 7168
    buffer_load_dwordx4 v[144:147], v4, s[8:11], s23 offen sc1
    buffer_load_dwordx2 v[148:149], v158, s[8:11], s45 offen offset:0 sc1
    buffer_load_dwordx2 v[150:151], v158, s[8:11], s45 offen offset:256 sc1
    buffer_load_dwordx2 v[152:153], v158, s[8:11], s45 offen offset:1024 sc1
    buffer_load_dwordx2 v[154:155], v158, s[8:11], s45 offen offset:1280 sc1
    s_waitcnt vmcnt(11)
    s_waitcnt lgkmcnt(8)
    v_mfma_f32_32x32x16_bf16 v[52:67], v[32:35], v[16:19], v[52:67]
    ds_read_b64_tr_b16 v[32:33], v3 offset:5120
    ds_read_b64_tr_b16 v[34:35], v3 offset:7680
    s_waitcnt lgkmcnt(8)
    v_mfma_f32_32x32x16_bf16 v[68:83], v[36:39], v[16:19], v[68:83]
    ds_read_b64_tr_b16 v[36:37], v3 offset:5184
    ds_read_b64_tr_b16 v[38:39], v3 offset:7744
    s_waitcnt lgkmcnt(8)
    v_mfma_f32_32x32x16_bf16 v[84:99], v[40:43], v[16:19], v[84:99]
    ds_read_b64_tr_b16 v[40:41], v3 offset:5248
    ds_read_b64_tr_b16 v[42:43], v3 offset:7808
    s_waitcnt lgkmcnt(8)
    v_mfma_f32_32x32x16_bf16 v[100:115], v[44:47], v[16:19], v[100:115]
    ds_read_b64_tr_b16 v[44:45], v3 offset:5312
    ds_read_b64_tr_b16 v[46:47], v3 offset:7872
    s_waitcnt lgkmcnt(8)
    v_mfma_f32_32x32x16_bf16 v[116:131], v[48:51], v[16:19], v[116:131]
    ds_read_b64_tr_b16 v[48:49], v3 offset:5376
    ds_read_b64_tr_b16 v[50:51], v3 offset:7936
    s_waitcnt lgkmcnt(8)
    s_waitcnt vmcnt(10)
    v_mfma_f32_32x32x16_bf16 v[52:67], v[32:35], v[20:23], v[52:67]
    ds_read_b64_tr_b16 v[32:33], v3 offset:10240
    ds_read_b64_tr_b16 v[34:35], v3 offset:12800
    s_add_u32 m0, s40, 0
    s_add_u32 s23, s41, 179200
    buffer_load_dwordx4 v5, s[16:19], s23 offen lds
    s_waitcnt lgkmcnt(8)
    v_mfma_f32_32x32x16_bf16 v[68:83], v[36:39], v[20:23], v[68:83]
    ds_read_b64_tr_b16 v[36:37], v3 offset:10304
    ds_read_b64_tr_b16 v[38:39], v3 offset:12864
    s_add_u32 m0, s40, 1024
    s_add_u32 s23, s41, 179200
    buffer_load_dwordx4 v6, s[16:19], s23 offen lds
    s_waitcnt lgkmcnt(8)
    v_mfma_f32_32x32x16_bf16 v[84:99], v[40:43], v[20:23], v[84:99]
    ds_read_b64_tr_b16 v[40:41], v3 offset:10368
    ds_read_b64_tr_b16 v[42:43], v3 offset:12928
    s_add_u32 m0, s40, 2048
    s_add_u32 s23, s41, 179200
    buffer_load_dwordx4 v7, s[16:19], s23 offen lds
    s_waitcnt lgkmcnt(8)
    v_mfma_f32_32x32x16_bf16 v[100:115], v[44:47], v[20:23], v[100:115]
    ds_read_b64_tr_b16 v[44:45], v3 offset:10432
    ds_read_b64_tr_b16 v[46:47], v3 offset:12992
    s_add_u32 m0, s40, 3072
    s_add_u32 s23, s41, 179200
    buffer_load_dwordx4 v8, s[16:19], s23 offen lds
    s_waitcnt lgkmcnt(8)
    v_mfma_f32_32x32x16_bf16 v[116:131], v[48:51], v[20:23], v[116:131]
    ds_read_b64_tr_b16 v[48:49], v3 offset:10496
    ds_read_b64_tr_b16 v[50:51], v3 offset:13056
    s_add_u32 m0, s40, 4096
    s_add_u32 s23, s41, 179200
    buffer_load_dwordx4 v9, s[16:19], s23 offen lds
    s_waitcnt lgkmcnt(8)
    s_waitcnt vmcnt(14)
    v_mfma_f32_32x32x16_bf16 v[52:67], v[32:35], v[24:27], v[52:67]
    ds_read_b64_tr_b16 v[32:33], v3 offset:15360
    ds_read_b64_tr_b16 v[34:35], v3 offset:17920
    s_add_u32 m0, s40, 5120
    s_add_u32 s23, s42, 0
    buffer_load_dwordx4 v10, s[16:19], s23 offen lds
    s_waitcnt lgkmcnt(8)
    v_mfma_f32_32x32x16_bf16 v[68:83], v[36:39], v[24:27], v[68:83]
    ds_read_b64_tr_b16 v[36:37], v3 offset:15424
    ds_read_b64_tr_b16 v[38:39], v3 offset:17984
    s_add_u32 m0, s40, 6144
    s_add_u32 s23, s42, 0
    buffer_load_dwordx4 v11, s[16:19], s23 offen lds
    s_waitcnt lgkmcnt(8)
    v_mfma_f32_32x32x16_bf16 v[84:99], v[40:43], v[24:27], v[84:99]
    ds_read_b64_tr_b16 v[40:41], v3 offset:15488
    ds_read_b64_tr_b16 v[42:43], v3 offset:18048
    s_add_u32 m0, s40, 7168
    s_add_u32 s23, s42, 0
    buffer_load_dwordx4 v12, s[16:19], s23 offen lds
    s_waitcnt lgkmcnt(8)
    v_mfma_f32_32x32x16_bf16 v[100:115], v[44:47], v[24:27], v[100:115]
    ds_read_b64_tr_b16 v[44:45], v3 offset:15552
    ds_read_b64_tr_b16 v[46:47], v3 offset:18112
    s_add_u32 m0, s40, 8192
    s_add_u32 s23, s42, 0
    buffer_load_dwordx4 v13, s[16:19], s23 offen lds
    s_waitcnt lgkmcnt(8)
    v_mfma_f32_32x32x16_bf16 v[116:131], v[48:51], v[24:27], v[116:131]
    ds_read_b64_tr_b16 v[48:49], v3 offset:15616
    ds_read_b64_tr_b16 v[50:51], v3 offset:18176
    s_add_u32 m0, s40, 9216
    s_add_u32 s23, s42, 0
    buffer_load_dwordx4 v14, s[16:19], s23 offen lds
    s_waitcnt lgkmcnt(8)
    s_waitcnt vmcnt(18)
    v_mfma_f32_32x32x16_bf16 v[52:67], v[32:35], v[28:31], v[52:67]
    ds_read_b64_tr_b16 v[32:33], v161 offset:0
    ds_read_b64_tr_b16 v[34:35], v161 offset:2560
    s_add_u32 m0, s40, 10240
    s_add_u32 s23, s42, 102400
    buffer_load_dwordx4 v10, s[16:19], s23 offen lds
    s_waitcnt lgkmcnt(8)
    v_mfma_f32_32x32x16_bf16 v[68:83], v[36:39], v[28:31], v[68:83]
    ds_read_b64_tr_b16 v[36:37], v161 offset:64
    ds_read_b64_tr_b16 v[38:39], v161 offset:2624
    s_add_u32 m0, s40, 11264
    s_add_u32 s23, s42, 102400
    buffer_load_dwordx4 v11, s[16:19], s23 offen lds
    s_waitcnt lgkmcnt(8)
    v_mfma_f32_32x32x16_bf16 v[84:99], v[40:43], v[28:31], v[84:99]
    ds_read_b64_tr_b16 v[40:41], v161 offset:128
    ds_read_b64_tr_b16 v[42:43], v161 offset:2688
    s_add_u32 m0, s40, 12288
    s_add_u32 s23, s42, 102400
    buffer_load_dwordx4 v12, s[16:19], s23 offen lds
    s_waitcnt lgkmcnt(8)
    v_mfma_f32_32x32x16_bf16 v[100:115], v[44:47], v[28:31], v[100:115]
    ds_read_b64_tr_b16 v[44:45], v161 offset:192
    ds_read_b64_tr_b16 v[46:47], v161 offset:2752
    s_add_u32 m0, s40, 13312
    s_add_u32 s23, s42, 102400
    buffer_load_dwordx4 v13, s[16:19], s23 offen lds
    s_waitcnt lgkmcnt(8)
    v_mfma_f32_32x32x16_bf16 v[116:131], v[48:51], v[28:31], v[116:131]
    ds_read_b64_tr_b16 v[48:49], v161 offset:256
    ds_read_b64_tr_b16 v[50:51], v161 offset:2816
    s_add_u32 m0, s40, 14336
    s_add_u32 s23, s42, 102400
    buffer_load_dwordx4 v14, s[16:19], s23 offen lds
    s_waitcnt lgkmcnt(8)
    s_waitcnt vmcnt(22)
    v_mfma_f32_32x32x16_bf16 v[52:67], v[32:35], v[132:135], v[52:67]
    ds_read_b64_tr_b16 v[32:33], v161 offset:5120
    ds_read_b64_tr_b16 v[34:35], v161 offset:7680
    s_waitcnt lgkmcnt(8)
    v_mfma_f32_32x32x16_bf16 v[68:83], v[36:39], v[132:135], v[68:83]
    ds_read_b64_tr_b16 v[36:37], v161 offset:5184
    ds_read_b64_tr_b16 v[38:39], v161 offset:7744
    s_waitcnt lgkmcnt(8)
    v_mfma_f32_32x32x16_bf16 v[84:99], v[40:43], v[132:135], v[84:99]
    ds_read_b64_tr_b16 v[40:41], v161 offset:5248
    ds_read_b64_tr_b16 v[42:43], v161 offset:7808
    s_waitcnt lgkmcnt(8)
    v_mfma_f32_32x32x16_bf16 v[100:115], v[44:47], v[132:135], v[100:115]
    ds_read_b64_tr_b16 v[44:45], v161 offset:5312
    ds_read_b64_tr_b16 v[46:47], v161 offset:7872
    s_waitcnt lgkmcnt(8)
    v_mfma_f32_32x32x16_bf16 v[116:131], v[48:51], v[132:135], v[116:131]
    ds_read_b64_tr_b16 v[48:49], v161 offset:5376
    ds_read_b64_tr_b16 v[50:51], v161 offset:7936
    s_waitcnt lgkmcnt(8)
    s_waitcnt vmcnt(21)
    v_mfma_f32_32x32x16_bf16 v[52:67], v[32:35], v[136:139], v[52:67]
    ds_read_b64_tr_b16 v[32:33], v161 offset:10240
    ds_read_b64_tr_b16 v[34:35], v161 offset:12800
    s_waitcnt lgkmcnt(8)
    v_mfma_f32_32x32x16_bf16 v[68:83], v[36:39], v[136:139], v[68:83]
    ds_read_b64_tr_b16 v[36:37], v161 offset:10304
    ds_read_b64_tr_b16 v[38:39], v161 offset:12864
    s_waitcnt lgkmcnt(8)
    v_mfma_f32_32x32x16_bf16 v[84:99], v[40:43], v[136:139], v[84:99]
    ds_read_b64_tr_b16 v[40:41], v161 offset:10368
    ds_read_b64_tr_b16 v[42:43], v161 offset:12928
    s_waitcnt lgkmcnt(8)
    v_mfma_f32_32x32x16_bf16 v[100:115], v[44:47], v[136:139], v[100:115]
    ds_read_b64_tr_b16 v[44:45], v161 offset:10432
    ds_read_b64_tr_b16 v[46:47], v161 offset:12992
    s_waitcnt lgkmcnt(8)
    v_mfma_f32_32x32x16_bf16 v[116:131], v[48:51], v[136:139], v[116:131]
    ds_read_b64_tr_b16 v[48:49], v161 offset:10496
    ds_read_b64_tr_b16 v[50:51], v161 offset:13056
    s_waitcnt lgkmcnt(8)
    s_waitcnt vmcnt(10)
    v_mfma_f32_32x32x16_bf16 v[52:67], v[32:35], v[140:143], v[52:67]
    ds_read_b64_tr_b16 v[32:33], v3 offset:0
    ds_read_b64_tr_b16 v[34:35], v3 offset:2560
    s_waitcnt lgkmcnt(8)
    v_mfma_f32_32x32x16_bf16 v[68:83], v[36:39], v[140:143], v[68:83]
    ds_read_b64_tr_b16 v[36:37], v3 offset:64
    ds_read_b64_tr_b16 v[38:39], v3 offset:2624
    s_waitcnt lgkmcnt(8)
    v_mfma_f32_32x32x16_bf16 v[84:99], v[40:43], v[140:143], v[84:99]
    ds_read_b64_tr_b16 v[40:41], v3 offset:128
    ds_read_b64_tr_b16 v[42:43], v3 offset:2688
    s_waitcnt lgkmcnt(8)
    v_mfma_f32_32x32x16_bf16 v[100:115], v[44:47], v[140:143], v[100:115]
    ds_read_b64_tr_b16 v[44:45], v3 offset:192
    ds_read_b64_tr_b16 v[46:47], v3 offset:2752
    s_waitcnt lgkmcnt(8)
    v_mfma_f32_32x32x16_bf16 v[116:131], v[48:51], v[140:143], v[116:131]
    ds_read_b64_tr_b16 v[48:49], v3 offset:256
    ds_read_b64_tr_b16 v[50:51], v3 offset:2816
    s_waitcnt lgkmcnt(8)
    s_waitcnt vmcnt(5)
    v_mfma_f32_32x32x16_bf16 v[52:67], v[32:35], v[144:147], v[52:67]
    ds_read_b64_tr_b16 v[32:33], v3 offset:5120
    ds_read_b64_tr_b16 v[34:35], v3 offset:7680
    s_waitcnt lgkmcnt(8)
    v_mfma_f32_32x32x16_bf16 v[68:83], v[36:39], v[144:147], v[68:83]
    ds_read_b64_tr_b16 v[36:37], v3 offset:5184
    ds_read_b64_tr_b16 v[38:39], v3 offset:7744
    s_waitcnt lgkmcnt(8)
    v_mfma_f32_32x32x16_bf16 v[84:99], v[40:43], v[144:147], v[84:99]
    ds_read_b64_tr_b16 v[40:41], v3 offset:5248
    ds_read_b64_tr_b16 v[42:43], v3 offset:7808
    s_waitcnt lgkmcnt(8)
    v_mfma_f32_32x32x16_bf16 v[100:115], v[44:47], v[144:147], v[100:115]
    ds_read_b64_tr_b16 v[44:45], v3 offset:5312
    ds_read_b64_tr_b16 v[46:47], v3 offset:7872
    s_waitcnt lgkmcnt(8)
    v_mfma_f32_32x32x16_bf16 v[116:131], v[48:51], v[144:147], v[116:131]
    ds_read_b64_tr_b16 v[48:49], v3 offset:5376
    ds_read_b64_tr_b16 v[50:51], v3 offset:7936
    s_waitcnt lgkmcnt(8)
    s_waitcnt vmcnt(0)
    v_mfma_f32_32x32x16_bf16 v[52:67], v[32:35], v[148:151], v[52:67]
    ds_read_b64_tr_b16 v[32:33], v3 offset:10240
    ds_read_b64_tr_b16 v[34:35], v3 offset:12800
    s_waitcnt lgkmcnt(8)
    v_mfma_f32_32x32x16_bf16 v[68:83], v[36:39], v[148:151], v[68:83]
    ds_read_b64_tr_b16 v[36:37], v3 offset:10304
    ds_read_b64_tr_b16 v[38:39], v3 offset:12864
    s_waitcnt lgkmcnt(8)
    v_mfma_f32_32x32x16_bf16 v[84:99], v[40:43], v[148:151], v[84:99]
    ds_read_b64_tr_b16 v[40:41], v3 offset:10368
    ds_read_b64_tr_b16 v[42:43], v3 offset:12928
    s_waitcnt lgkmcnt(8)
    v_mfma_f32_32x32x16_bf16 v[100:115], v[44:47], v[148:151], v[100:115]
    ds_read_b64_tr_b16 v[44:45], v3 offset:10432
    ds_read_b64_tr_b16 v[46:47], v3 offset:12992
    s_waitcnt lgkmcnt(8)
    v_mfma_f32_32x32x16_bf16 v[116:131], v[48:51], v[148:151], v[116:131]
    ds_read_b64_tr_b16 v[48:49], v3 offset:10496
    ds_read_b64_tr_b16 v[50:51], v3 offset:13056
    s_waitcnt lgkmcnt(8)
    v_mfma_f32_32x32x16_bf16 v[52:67], v[32:35], v[152:155], v[52:67]
    s_waitcnt lgkmcnt(6)
    v_mfma_f32_32x32x16_bf16 v[68:83], v[36:39], v[152:155], v[68:83]
    s_waitcnt lgkmcnt(4)
    v_mfma_f32_32x32x16_bf16 v[84:99], v[40:43], v[152:155], v[84:99]
    s_waitcnt lgkmcnt(2)
    v_mfma_f32_32x32x16_bf16 v[100:115], v[44:47], v[152:155], v[100:115]
    s_waitcnt lgkmcnt(0)
    v_mfma_f32_32x32x16_bf16 v[116:131], v[48:51], v[152:155], v[116:131]
    v_and_b32 v156, 31, v2
    v_mul_u32_u24 v156, 656, v156
    v_lshrrev_b32 v157, 5, v2
    v_lshl_add_u32 v156, v157, 4, v156
    v_add_u32 v156, s40, v156
    v_mov_b32 v158, 65096
    v_mov_b32 v159, 1
    v_subrev_u32 v160, 512, v0
    v_add_u32 v16, 0, v160
    v_mul_u32_u24 v17, 52429, v16
    v_lshrrev_b32 v17, 20, v17
    v_mul_u32_u24 v18, 20, v17
    v_sub_u32 v18, v16, v18
    v_mul_u32_u24 v19, 1280, v17
    v_lshl_add_u32 v161, v18, 4, v19
    v_mul_u32_u24 v19, 656, v17
    v_lshl_add_u32 v19, v18, 5, v19
    v_add_u32 v164, 65280, v19
    v_add_u32 v16, 256, v160
    v_mul_u32_u24 v17, 52429, v16
    v_lshrrev_b32 v17, 20, v17
    v_mul_u32_u24 v18, 20, v17
    v_sub_u32 v18, v16, v18
    v_mul_u32_u24 v19, 1280, v17
    v_lshl_add_u32 v162, v18, 4, v19
    v_mul_u32_u24 v19, 656, v17
    v_lshl_add_u32 v19, v18, 5, v19
    v_add_u32 v165, 65280, v19
    v_add_u32 v16, 512, v160
    v_mul_u32_u24 v17, 52429, v16
    v_lshrrev_b32 v17, 20, v17
    v_mul_u32_u24 v18, 20, v17
    v_sub_u32 v18, v16, v18
    v_mul_u32_u24 v19, 1280, v17
    v_lshl_add_u32 v163, v18, 4, v19
    v_mul_u32_u24 v19, 656, v17
    v_lshl_add_u32 v19, v18, 5, v19
    v_add_u32 v166, 65280, v19
    ds_write_b128 v156, v[52:55] offset:0
    ds_write_b128 v156, v[56:59] offset:32
    ds_write_b128 v156, v[60:63] offset:64
    ds_write_b128 v156, v[64:67] offset:96
    ds_write_b128 v156, v[68:71] offset:128
    ds_write_b128 v156, v[72:75] offset:160
    ds_write_b128 v156, v[76:79] offset:192
    ds_write_b128 v156, v[80:83] offset:224
    ds_write_b128 v156, v[84:87] offset:256
    ds_write_b128 v156, v[88:91] offset:288
    ds_write_b128 v156, v[92:95] offset:320
    ds_write_b128 v156, v[96:99] offset:352
    ds_write_b128 v156, v[100:103] offset:384
    ds_write_b128 v156, v[104:107] offset:416
    ds_write_b128 v156, v[108:111] offset:448
    ds_write_b128 v156, v[112:115] offset:480
    ds_write_b128 v156, v[116:119] offset:512
    ds_write_b128 v156, v[120:123] offset:544
    ds_write_b128 v156, v[124:127] offset:576
    ds_write_b128 v156, v[128:131] offset:608
    s_waitcnt lgkmcnt(0)
    s_mov_b64 exec, 1
    ds_add_u32 v158, v159
    s_mov_b64 exec, -1
    s_mov_b32 s24, 4
    s_mov_b32 s78, 0x40000
L_wait_gred:
    ds_read_b32 v167, v158
    s_waitcnt lgkmcnt(0)
    v_readfirstlane_b32 s23, v167
    s_sub_u32 s78, s78, 1
    s_cbranch_scc1 L_go_gred
    s_cmp_ge_u32 s23, s24
    s_cbranch_scc1 L_go_gred
    s_sleep 1
    s_branch L_wait_gred
L_go_gred:
    v_cmp_gt_u32 vcc, 128, v160
    ds_read_b128 v[16:19], v164 offset:0
    ds_read_b128 v[20:23], v164 offset:16
    ds_read_b128 v[24:27], v164 offset:20992
    ds_read_b128 v[28:31], v164 offset:21008
    ds_read_b128 v[32:35], v164 offset:41984
    ds_read_b128 v[36:39], v164 offset:42000
    ds_read_b128 v[40:43], v164 offset:62976
    ds_read_b128 v[44:47], v164 offset:62992
    s_waitcnt lgkmcnt(4)
    ds_read_b128 v[52:55], v165 offset:0
    ds_read_b128 v[56:59], v165 offset:16
    ds_read_b128 v[60:63], v165 offset:20992
    ds_read_b128 v[64:67], v165 offset:21008
    ds_read_b128 v[68:71], v165 offset:41984
    ds_read_b128 v[72:75], v165 offset:42000
    ds_read_b128 v[76:79], v165 offset:62976
    ds_read_b128 v[80:83], v165 offset:62992
    s_waitcnt lgkmcnt(8)
    v_add_f32 v16, v16, v24
    v_add_f32 v32, v32, v40
    v_add_f32 v17, v17, v25
    v_add_f32 v33, v33, v41
    v_add_f32 v18, v18, v26
    v_add_f32 v34, v34, v42
    v_add_f32 v19, v19, v27
    v_add_f32 v35, v35, v43
    v_add_f32 v20, v20, v28
    v_add_f32 v36, v36, v44
    v_add_f32 v21, v21, v29
    v_add_f32 v37, v37, v45
    v_add_f32 v22, v22, v30
    v_add_f32 v38, v38, v46
    v_add_f32 v23, v23, v31
    v_add_f32 v39, v39, v47
    v_add_f32 v16, v16, v32
    v_add_f32 v17, v17, v33
    v_add_f32 v18, v18, v34
    v_add_f32 v19, v19, v35
    v_add_f32 v20, v20, v36
    v_add_f32 v21, v21, v37
    v_add_f32 v22, v22, v38
    v_add_f32 v23, v23, v39
    v_cvt_pk_bf16_f32 v24, v16, v17
    v_cvt_pk_bf16_f32 v25, v18, v19
    v_cvt_pk_bf16_f32 v26, v20, v21
    v_cvt_pk_bf16_f32 v27, v22, v23
    buffer_store_dwordx4 v[24:27], v161, s[36:39], s46 offen
    s_and_saveexec_b64 s[50:51], vcc
    s_cbranch_execz L_main_last
    ds_read_b128 v[88:91], v166 offset:0
    ds_read_b128 v[92:95], v166 offset:16
    ds_read_b128 v[96:99], v166 offset:20992
    ds_read_b128 v[100:103], v166 offset:21008
    ds_read_b128 v[104:107], v166 offset:41984
    ds_read_b128 v[108:111], v166 offset:42000
    ds_read_b128 v[112:115], v166 offset:62976
    ds_read_b128 v[116:119], v166 offset:62992
    s_mov_b64 exec, -1
    s_waitcnt lgkmcnt(8)
    v_add_f32 v52, v52, v60
    v_add_f32 v68, v68, v76
    v_add_f32 v53, v53, v61
    v_add_f32 v69, v69, v77
    v_add_f32 v54, v54, v62
    v_add_f32 v70, v70, v78
    v_add_f32 v55, v55, v63
    v_add_f32 v71, v71, v79
    v_add_f32 v56, v56, v64
    v_add_f32 v72, v72, v80
    v_add_f32 v57, v57, v65
    v_add_f32 v73, v73, v81
    v_add_f32 v58, v58, v66
    v_add_f32 v74, v74, v82
    v_add_f32 v59, v59, v67
    v_add_f32 v75, v75, v83
    v_add_f32 v52, v52, v68
    v_add_f32 v53, v53, v69
    v_add_f32 v54, v54, v70
    v_add_f32 v55, v55, v71
    v_add_f32 v56, v56, v72
    v_add_f32 v57, v57, v73
    v_add_f32 v58, v58, v74
    v_add_f32 v59, v59, v75
    v_cvt_pk_bf16_f32 v60, v52, v53
    v_cvt_pk_bf16_f32 v61, v54, v55
    v_cvt_pk_bf16_f32 v62, v56, v57
    v_cvt_pk_bf16_f32 v63, v58, v59
    buffer_store_dwordx4 v[60:63], v162, s[36:39], s46 offen
    s_and_b64 exec, exec, vcc
    s_waitcnt lgkmcnt(0)
    v_add_f32 v88, v88, v96
    v_add_f32 v104, v104, v112
    v_add_f32 v89, v89, v97
    v_add_f32 v105, v105, v113
    v_add_f32 v90, v90, v98
    v_add_f32 v106, v106, v114
    v_add_f32 v91, v91, v99
    v_add_f32 v107, v107, v115
    v_add_f32 v92, v92, v100
    v_add_f32 v108, v108, v116
    v_add_f32 v93, v93, v101
    v_add_f32 v109, v109, v117
    v_add_f32 v94, v94, v102
    v_add_f32 v110, v110, v118
    v_add_f32 v95, v95, v103
    v_add_f32 v111, v111, v119
    v_add_f32 v88, v88, v104
    v_add_f32 v89, v89, v105
    v_add_f32 v90, v90, v106
    v_add_f32 v91, v91, v107
    v_add_f32 v92, v92, v108
    v_add_f32 v93, v93, v109
    v_add_f32 v94, v94, v110
    v_add_f32 v95, v95, v111
    v_cvt_pk_bf16_f32 v96, v88, v89
    v_cvt_pk_bf16_f32 v97, v90, v91
    v_cvt_pk_bf16_f32 v98, v92, v93
    v_cvt_pk_bf16_f32 v99, v94, v95
    buffer_store_dwordx4 v[96:99], v163, s[36:39], s46 offen
    s_branch L_main_gdone
L_main_last:
    s_mov_b64 exec, -1
    s_waitcnt lgkmcnt(0)
    v_add_f32 v52, v52, v60
    v_add_f32 v68, v68, v76
    v_add_f32 v53, v53, v61
    v_add_f32 v69, v69, v77
    v_add_f32 v54, v54, v62
    v_add_f32 v70, v70, v78
    v_add_f32 v55, v55, v63
    v_add_f32 v71, v71, v79
    v_add_f32 v56, v56, v64
    v_add_f32 v72, v72, v80
    v_add_f32 v57, v57, v65
    v_add_f32 v73, v73, v81
    v_add_f32 v58, v58, v66
    v_add_f32 v74, v74, v82
    v_add_f32 v59, v59, v67
    v_add_f32 v75, v75, v83
    v_add_f32 v52, v52, v68
    v_add_f32 v53, v53, v69
    v_add_f32 v54, v54, v70
    v_add_f32 v55, v55, v71
    v_add_f32 v56, v56, v72
    v_add_f32 v57, v57, v73
    v_add_f32 v58, v58, v74
    v_add_f32 v59, v59, v75
    v_cvt_pk_bf16_f32 v60, v52, v53
    v_cvt_pk_bf16_f32 v61, v54, v55
    v_cvt_pk_bf16_f32 v62, v56, v57
    v_cvt_pk_bf16_f32 v63, v58, v59
    buffer_store_dwordx4 v[60:63], v162, s[36:39], s46 offen
L_main_gdone:
    s_mov_b64 exec, -1
L_main_end:
    s_endpgm
.fill 256, 4, 0xBF800000
.section .rodata,"a"
.p2align 6
.amdhsa_kernel proj_kernel
  .amdhsa_next_free_vgpr 256
  .amdhsa_next_free_sgpr 96
  .amdhsa_accum_offset 256
  .amdhsa_group_segment_fixed_size 0
  .amdhsa_kernarg_size 80
  .amdhsa_user_sgpr_count 2
  .amdhsa_user_sgpr_kernarg_segment_ptr 1
  .amdhsa_system_sgpr_workgroup_id_x 1
.end_amdhsa_kernel
.p2align 6
.amdhsa_kernel main_kernel
  .amdhsa_next_free_vgpr 168
  .amdhsa_next_free_sgpr 96
  .amdhsa_accum_offset 168
  .amdhsa_group_segment_fixed_size 0
  .amdhsa_kernarg_size 80
  .amdhsa_user_sgpr_count 2
  .amdhsa_user_sgpr_kernarg_segment_ptr 1
  .amdhsa_system_sgpr_workgroup_id_x 1
.end_amdhsa_kernel
```
